```python
import torch

def _softmax(x, axis=-1):
    return torch.softmax(x, dim=axis)

def _gelu(x):
    return torch.nn.functional.gelu(x, approximate='tanh')

def _silu(x):
    return torch.nn.functional.silu(x)

def _sigmoid(x):
    return torch.sigmoid(x)

def _layernorm(x, axis=-1, eps=1e-05):
    m = x.mean(dim=axis, keepdim=True)
    v = x.var(dim=axis, keepdim=True, unbiased=False)
    return (x - m) / torch.sqrt(v + eps)

def _scatter_add(tgt, idx, src, axis=0):
    return tgt.clone().index_add_(axis, idx, src)

def _segment_sum(src, seg, n):
    out = torch.zeros((n,) + src.shape[1:], dtype=src.dtype)
    return out.index_add_(0, seg, src)

def _pad(x, pw):
    flat = tuple((v for pair in reversed(pw) for v in pair))
    return torch.nn.functional.pad(x, flat)
kernel_name = 'adaLN_cond__gqa_block_cached__geglu_ffn__decode'

def setup_inputs():

    _w = lambda a: (lambda t: t.to(torch.bfloat16) if t.is_floating_point() else t)(torch.as_tensor(a))

    def _A_setup():
        B, Sq, D = (1, 1, 512)
        Hq, Hkv, Sk, Dh = (32, 8, 16384, 128)
        assert Hq % Hkv == 0, (Hq, Hkv)
        return {'x': _w((lambda *s: torch.randn(*s, dtype=torch.bfloat16) * 0.1)(B, Sq, D)), 'k_cache': _w((lambda *s: torch.randn(*s, dtype=torch.bfloat16) * 0.8)(B, Hkv, Sk, Dh)), 'v_cache': _w((lambda *s: torch.randn(*s, dtype=torch.bfloat16) * 0.8)(B, Hkv, Sk, Dh)), 'wq': _w((lambda *s: torch.randn(*s, dtype=torch.bfloat16) * 0.8)(D, Hq * Dh) * D ** (-0.5)), 'wo': _w((lambda *s: torch.randn(*s, dtype=torch.bfloat16) * 0.8)(Hq * Dh, D) * (Hq * Dh) ** (-0.5))}
    _A_in = _A_setup()

    def _B_setup():
        B, S, D, F = (1, 1, 512, 1792)
        return {'x': _w((lambda *s: torch.randn(*s, dtype=torch.bfloat16) * 0.1)(B, S, D)), 'w_gate': _w((lambda *s: torch.randn(*s, dtype=torch.bfloat16) * 0.1)(D, F)), 'w_up': _w((lambda *s: torch.randn(*s, dtype=torch.bfloat16) * 0.1)(D, F)), 'w_down': _w((lambda *s: torch.randn(*s, dtype=torch.bfloat16) * 0.1)(F, D))}
    _B_in = _B_setup()
    return {'A_x': _A_in['x'], 'A_k_cache': _A_in['k_cache'], 'A_v_cache': _A_in['v_cache'], 'A_wq': _A_in['wq'], 'A_wo': _A_in['wo'], 'B_x': _B_in['x'], 'B_w_gate': _B_in['w_gate'], 'B_w_up': _B_in['w_up'], 'B_w_down': _B_in['w_down'], 'c': _w((lambda *s: torch.randn(*s, dtype=torch.bfloat16) * 0.4)(1, 512) * 8.0), 'w_mod': _w((lambda *s: torch.randn(*s, dtype=torch.bfloat16) * 0.4)(512, 6 * 512) * 512 ** (-0.5) * 8.0)}

def reference(A_x, A_k_cache, A_v_cache, A_wq, A_wo, B_x, B_w_gate, B_w_up, B_w_down, c, w_mod):

    def _A_ref(x, k_cache, v_cache, wq, wo):
        B, Sq, D = x.shape
        Hq, Dh = (32, 128)
        Hkv = k_cache.shape[1]
        rep = Hq // Hkv
        q = (lambda x, *d: x.permute(*d))((x @ wq).reshape(B, Sq, Hq, Dh), 0, 2, 1, 3)
        k = (lambda x, n, axis: torch.repeat_interleave(x, n, dim=axis))(k_cache, rep, axis=1)
        v = (lambda x, n, axis: torch.repeat_interleave(x, n, dim=axis))(v_cache, rep, axis=1)
        scores = torch.einsum('bhqd,bhkd->bhqk', q, k) * Dh ** (-0.5)
        p = _softmax(scores, axis=-1)
        o = torch.einsum('bhqk,bhkd->bhqd', p, v)
        return (lambda x, *d: x.permute(*d))(o, 0, 2, 1, 3).reshape(B, Sq, Hq * Dh) @ wo

    def _B_ref(x, w_gate, w_up, w_down):
        return _gelu(x @ w_gate) * (x @ w_up) @ w_down
    x = A_x
    mod = (_silu(c) @ w_mod).reshape(c.shape[0], 6, 1, -1)
    sa, ca, ga, sb, cb, gb = (mod[:, 0].clone(), mod[:, 1].clone(), mod[:, 2].clone(), mod[:, 3].clone(), mod[:, 4].clone(), mod[:, 5].clone())
    h = _layernorm(x, axis=-1) * (1 + ca) + sa
    x = x + ga * _A_ref(h, A_k_cache, A_v_cache, A_wq, A_wo)
    h = _layernorm(x, axis=-1) * (1 + cb) + sb
    x = x + gb * _B_ref(h, B_w_gate, B_w_up, B_w_down)
    return x
```

```asm
; @launch grid=(256,1,1) block=(512,1,1) lds=30720
.amdgcn_target "amdgcn-amd-amdhsa--gfx950"
.text
.globl adaLN_cond__gqa_block_cached__geglu_ffn__decode_kernel
.p2align 8
.type adaLN_cond__gqa_block_cached__geglu_ffn__decode_kernel,@function
adaLN_cond__gqa_block_cached__geglu_ffn__decode_kernel:
  s_cmp_ge_u32 s2, 0x100
  s_cbranch_scc1 L_end
  s_load_dwordx16 s[8:23], s[0:1], 0
  s_load_dwordx8 s[24:31], s[0:1], 64
  s_load_dwordx4 s[32:35], s[0:1], 96
  v_lshrrev_b32 v1, 6, v0
  v_and_b32 v0, 63, v0
  v_readfirstlane_b32 s3, v1
  s_add_u32 s4, s2, 0
  s_and_b32 s4, s4, 7
  s_lshr_b32 s5, s2, 3
  s_mov_b64 s[6:7], -1
  v_mov_b32 v1, 0
  v_lshlrev_b32 v2, 4, v0
  s_getpc_b64 s[44:45]
L_pc1:
  s_sub_u32 s44, s44, L_pc1-adaLN_cond__gqa_block_cached__geglu_ffn__decode_kernel
  s_subb_u32 s45, s45, 0
  s_mul_i32 s46, s3, 3072
  v_add_u32 v3, s46, v2
  global_load_dwordx4 v[16:19], v3, s[44:45] offset:0
  global_load_dwordx4 v[20:23], v3, s[44:45] offset:1024
  global_load_dwordx4 v[24:27], v3, s[44:45] offset:2048
  s_mov_b32 s48, 0x05040100
  s_mov_b32 s49, 0x07060302
  s_mul_i32 s51, s5, 7
  s_add_u32 s60, s51, s4
  s_mul_i32 s51, s60, 2341
  s_lshr_b32 s51, s51, 16
  s_mul_i32 s46, s51, 28
  s_sub_u32 s52, s60, s46
  s_xor_b32 s53, s5, 0
  s_mov_b32 s47, 0
  s_mov_b32 s62, 0
  s_mov_b32 s38, 0x400000
  s_mov_b32 s39, 0x20000
  s_mov_b32 s42, 0x400000
  s_mov_b32 s43, 0x20000
  s_lshl_b32 s46, s51, 22
  s_waitcnt lgkmcnt(0)
  s_add_u32 s36, s10, s46
  s_addc_u32 s37, s11, 0
  s_and_b32 s37, s37, 0xffff
  s_add_u32 s40, s12, s46
  s_addc_u32 s41, s13, 0
  s_and_b32 s41, s41, 0xffff
  s_cmp_eq_u32 s4, 7
  s_cbranch_scc1 L_tail_stream
  s_cmp_eq_u32 s3, 0
  s_cbranch_scc1 L_chain
  s_sub_u32 s46, s3, 1
  s_cmp_eq_u32 s52, 27
  s_cselect_b32 s54, 3, 5
  s_cselect_b32 s55, 4, 2
  s_mul_i32 s56, s46, s54
  s_min_u32 s57, s46, s55
  s_add_u32 s56, s56, s57
  s_mul_i32 s57, s52, 37
  s_add_u32 s56, s56, s57
  s_cmp_lt_u32 s46, s55
  s_addc_u32 s54, s54, 0
  s_lshl_b32 s55, s56, 12
  v_bfe_u32 v3, v0, 2, 2
  v_lshlrev_b32 v3, 8, v3
  v_lshrrev_b32 v14, 4, v0
  v_lshl_add_u32 v3, v14, 6, v3
  v_and_b32 v14, 3, v0
  v_lshl_add_u32 v3, v14, 4, v3
  s_cmp_ge_u32 s60, 64
  s_cbranch_scc1 L_pre_a
  s_barrier
L_pre_a:
  s_add_u32 s46, s55, 0
  buffer_load_dwordx4 v[64:67], v3, s[36:39], s46 offen offset:0 nt
  buffer_load_dwordx4 v[68:71], v3, s[36:39], s46 offen offset:1024 nt
  buffer_load_dwordx4 v[72:75], v3, s[36:39], s46 offen offset:2048 nt
  buffer_load_dwordx4 v[76:79], v3, s[36:39], s46 offen offset:3072 nt
  s_cmp_gt_u32 s54, 3
  s_cselect_b32 s72, 0, 0xff800000
  s_cmp_gt_u32 s54, 4
  s_cselect_b32 s73, 0, 0xff800000
  s_cmp_gt_u32 s54, 5
  s_cselect_b32 s74, 0, 0xff800000
  s_getpc_b64 s[100:101]
L_pc0:
  s_add_u32 s100, s100, L_att_kphase-L_pc0
  s_addc_u32 s101, s101, 0
  s_cmp_lt_u32 s60, 64
  s_cbranch_scc1 L_pre_b
  s_barrier
L_pre_b:
  s_add_u32 s46, s55, 4096
  buffer_load_dwordx4 v[80:83], v3, s[36:39], s46 offen offset:0 nt
  buffer_load_dwordx4 v[84:87], v3, s[36:39], s46 offen offset:1024 nt
  buffer_load_dwordx4 v[88:91], v3, s[36:39], s46 offen offset:2048 nt
  buffer_load_dwordx4 v[92:95], v3, s[36:39], s46 offen offset:3072 nt
  s_cmp_lg_u32 s3, 7
  s_cbranch_scc1 Ld_1
  s_mov_b64 s[6:7], 0
  s_mov_b64 exec, 0
  s_swappc_b64 s[98:99], s[100:101]
  s_branch L_att_vphase
L_att_dry_ret:
  s_mov_b64 s[6:7], -1
  s_mov_b64 exec, -1
Ld_1:
  s_cmp_lg_u32 s47, 0
  s_cbranch_scc1 Lt_2
  s_waitcnt vmcnt(2)
Lt_2:
  s_add_u32 s46, s55, 8192
  buffer_load_dwordx4 v[96:99], v3, s[36:39], s46 offen offset:0 nt
  buffer_load_dwordx4 v[100:103], v3, s[36:39], s46 offen offset:1024 nt
  buffer_load_dwordx4 v[104:107], v3, s[36:39], s46 offen offset:2048 nt
  buffer_load_dwordx4 v[108:111], v3, s[36:39], s46 offen offset:3072 nt
  s_cmp_lg_u32 s47, 0
  s_cbranch_scc1 Lt_3
  s_waitcnt vmcnt(2)
Lt_3:
  s_cmp_gt_u32 s54, 3
  s_cselect_b32 s38, 0x400000, 0
  s_add_u32 s46, s55, 12288
  buffer_load_dwordx4 v[112:115], v3, s[36:39], s46 offen offset:0 nt
  buffer_load_dwordx4 v[116:119], v3, s[36:39], s46 offen offset:1024 nt
  buffer_load_dwordx4 v[120:123], v3, s[36:39], s46 offen offset:2048 nt
  buffer_load_dwordx4 v[124:127], v3, s[36:39], s46 offen offset:3072 nt
  s_cmp_lg_u32 s47, 0
  s_cbranch_scc1 Lt_4
  s_waitcnt vmcnt(2)
Lt_4:
  s_cmp_gt_u32 s54, 4
  s_cselect_b32 s38, 0x400000, 0
  s_add_u32 s46, s55, 16384
  buffer_load_dwordx4 v[128:131], v3, s[36:39], s46 offen offset:0 nt
  buffer_load_dwordx4 v[132:135], v3, s[36:39], s46 offen offset:1024 nt
  buffer_load_dwordx4 v[136:139], v3, s[36:39], s46 offen offset:2048 nt
  buffer_load_dwordx4 v[140:143], v3, s[36:39], s46 offen offset:3072 nt
  s_cmp_lg_u32 s47, 0
  s_cbranch_scc1 Lt_5
  s_waitcnt vmcnt(2)
Lt_5:
  s_cmp_gt_u32 s54, 5
  s_cselect_b32 s38, 0x400000, 0
  s_add_u32 s46, s55, 20480
  buffer_load_dwordx4 v[144:147], v3, s[36:39], s46 offen offset:0 nt
  buffer_load_dwordx4 v[148:151], v3, s[36:39], s46 offen offset:1024 nt
  buffer_load_dwordx4 v[152:155], v3, s[36:39], s46 offen offset:2048 nt
  buffer_load_dwordx4 v[156:159], v3, s[36:39], s46 offen offset:3072 nt
  s_cmp_lg_u32 s47, 0
  s_cbranch_scc1 Lt_6
  s_waitcnt vmcnt(2)
Lt_6:
  s_add_u32 s46, s55, 0
  buffer_load_dwordx4 v[160:163], v2, s[40:43], s46 offen offset:0 nt
  buffer_load_dwordx4 v[164:167], v2, s[40:43], s46 offen offset:1024 nt
  buffer_load_dwordx4 v[168:171], v2, s[40:43], s46 offen offset:2048 nt
  buffer_load_dwordx4 v[172:175], v2, s[40:43], s46 offen offset:3072 nt
  s_cmp_lg_u32 s47, 0
  s_cbranch_scc1 Lt_7
  s_waitcnt vmcnt(2)
  ds_read_b32 v15, v1 offset:0
  s_waitcnt lgkmcnt(0)
  v_readfirstlane_b32 s47, v15
  s_nop 0
  s_cmp_eq_u32 s47, 0
  s_cbranch_scc1 Lt_7
  s_swappc_b64 s[98:99], s[100:101]
  s_nop 0
Lt_7:
  s_add_u32 s46, s55, 4096
  buffer_load_dwordx4 v[176:179], v2, s[40:43], s46 offen offset:0 nt
  buffer_load_dwordx4 v[180:183], v2, s[40:43], s46 offen offset:1024 nt
  buffer_load_dwordx4 v[184:187], v2, s[40:43], s46 offen offset:2048 nt
  buffer_load_dwordx4 v[188:191], v2, s[40:43], s46 offen offset:3072 nt
  s_cmp_lg_u32 s47, 0
  s_cbranch_scc1 Lt_8
  s_waitcnt vmcnt(2)
  ds_read_b32 v15, v1 offset:0
  s_waitcnt lgkmcnt(0)
  v_readfirstlane_b32 s47, v15
  s_nop 0
  s_cmp_eq_u32 s47, 0
  s_cbranch_scc1 Lt_8
  s_swappc_b64 s[98:99], s[100:101]
  s_nop 0
Lt_8:
  s_add_u32 s46, s55, 8192
  buffer_load_dwordx4 v[192:195], v2, s[40:43], s46 offen offset:0 nt
  buffer_load_dwordx4 v[196:199], v2, s[40:43], s46 offen offset:1024 nt
  buffer_load_dwordx4 v[200:203], v2, s[40:43], s46 offen offset:2048 nt
  buffer_load_dwordx4 v[204:207], v2, s[40:43], s46 offen offset:3072 nt
  s_cmp_lg_u32 s47, 0
  s_cbranch_scc1 Lt_9
  ds_read_b32 v15, v1 offset:0
  s_waitcnt lgkmcnt(0)
  v_readfirstlane_b32 s47, v15
  s_nop 0
  s_cmp_eq_u32 s47, 0
  s_cbranch_scc1 Lt_9
  s_waitcnt vmcnt(12)
  s_swappc_b64 s[98:99], s[100:101]
Lt_9:
  s_cmp_gt_u32 s54, 3
  s_cselect_b32 s42, 0x400000, 0
  s_add_u32 s46, s55, 12288
  buffer_load_dwordx4 v[208:211], v2, s[40:43], s46 offen offset:0 nt
  buffer_load_dwordx4 v[212:215], v2, s[40:43], s46 offen offset:1024 nt
  buffer_load_dwordx4 v[216:219], v2, s[40:43], s46 offen offset:2048 nt
  buffer_load_dwordx4 v[220:223], v2, s[40:43], s46 offen offset:3072 nt
  s_cmp_lg_u32 s47, 0
  s_cbranch_scc1 Lt_10
  ds_read_b32 v15, v1 offset:0
  s_waitcnt lgkmcnt(0)
  v_readfirstlane_b32 s47, v15
  s_nop 0
  s_cmp_eq_u32 s47, 0
  s_cbranch_scc1 Lt_10
  s_waitcnt vmcnt(16)
  s_swappc_b64 s[98:99], s[100:101]
Lt_10:
  s_cmp_gt_u32 s54, 4
  s_cselect_b32 s42, 0x400000, 0
  s_add_u32 s46, s55, 16384
  buffer_load_dwordx4 v[224:227], v2, s[40:43], s46 offen offset:0 nt
  buffer_load_dwordx4 v[228:231], v2, s[40:43], s46 offen offset:1024 nt
  buffer_load_dwordx4 v[232:235], v2, s[40:43], s46 offen offset:2048 nt
  buffer_load_dwordx4 v[236:239], v2, s[40:43], s46 offen offset:3072 nt
  s_cmp_lg_u32 s47, 0
  s_cbranch_scc1 Lt_11
  ds_read_b32 v15, v1 offset:0
  s_waitcnt lgkmcnt(0)
  v_readfirstlane_b32 s47, v15
  s_nop 0
  s_cmp_eq_u32 s47, 0
  s_cbranch_scc1 Lt_11
  s_waitcnt vmcnt(20)
  s_swappc_b64 s[98:99], s[100:101]
Lt_11:
  s_cmp_gt_u32 s54, 5
  s_cselect_b32 s42, 0x400000, 0
  s_add_u32 s46, s55, 20480
  buffer_load_dwordx4 v[240:243], v2, s[40:43], s46 offen offset:0 nt
  buffer_load_dwordx4 v[244:247], v2, s[40:43], s46 offen offset:1024 nt
  buffer_load_dwordx4 v[248:251], v2, s[40:43], s46 offen offset:2048 nt
  buffer_load_dwordx4 v[252:255], v2, s[40:43], s46 offen offset:3072 nt
  s_cmp_lg_u32 s47, 0
  s_cbranch_scc1 L_att_vphase
  s_mov_b32 s63, 262144
Lp_12:
  s_sub_u32 s63, s63, 1
  s_cbranch_scc1 Lq_13
  s_sleep 1
  ds_read_b32 v15, v1 offset:0
  s_waitcnt lgkmcnt(0)
  v_cmp_eq_u32 vcc, 0, v15
  s_cbranch_vccnz Lp_12
Lq_13:
  s_waitcnt vmcnt(24)
  s_swappc_b64 s[98:99], s[100:101]
  s_branch L_att_vphase
L_chain:
  s_setprio 3
  global_load_dword v10, v1, s[34:35] offset:0 sc1
  s_lshr_b32 s57, s60, 6
  v_lshlrev_b32 v13, 2, v0
  ds_write_b32 v13, v1 offset:0
  ds_write_b32 v13, v1 offset:256
  v_lshrrev_b32 v14, 3, v0
  v_lshlrev_b32 v14, 4, v14
  v_and_b32 v15, 7, v0
  v_lshlrev_b32 v15, 4, v15
  s_mov_b32 s44, s28
  s_mov_b32 s45, s29
  s_movk_i32 s61, 6144
  s_and_b32 s54, s60, 15
  s_lshr_b32 s55, s60, 4
  s_lshl_b32 s56, s55, 13
  s_lshl_b32 s46, s54, 9
  s_add_u32 s56, s56, s46
  s_add_u32 s56, s56, 0x1000
  s_lshl_b32 s54, s54, 7
  s_cmp_lt_u32 s60, 64
  s_cbranch_scc1 L_ch_isM
  s_sub_u32 s46, s60, 64
  s_and_b32 s54, s46, 31
  s_lshr_b32 s55, s46, 5
  s_lshl_b32 s56, s55, 14
  s_lshl_b32 s46, s54, 9
  s_add_u32 s56, s56, s46
  s_add_u32 s56, s56, 0x9000
  s_lshl_b32 s54, s54, 7
  s_add_u32 s54, s54, 2048
  s_cmp_lt_u32 s60, 192
  s_cbranch_scc1 L_ch_isM
  s_sub_u32 s54, s60, 160
  s_mov_b32 s55, 3
  s_lshl_b32 s56, s54, 9
  s_add_u32 s56, s56, 0x31000
  s_lshl_b32 s54, s54, 7
  s_mov_b32 s44, s14
  s_mov_b32 s45, s15
  s_movk_i32 s61, 8192
L_ch_isM:
  s_lshl_b32 s46, s55, 8
  v_add_u32 v3, s46, v13
  global_load_dword v8, v3, s[26:27]
  s_lshl_b32 s46, s55, 7
  v_add_u32 v3, s46, v14
  v_mul_lo_u32 v3, v3, s61
  v_add3_u32 v3, v3, v15, s54
  global_load_dwordx4 v[16:19], v3, s[44:45] nt
  s_add_u32 s44, s44, s61
  s_addc_u32 s45, s45, 0
  global_load_dwordx4 v[20:23], v3, s[44:45] nt
  s_add_u32 s44, s44, s61
  s_addc_u32 s45, s45, 0
  global_load_dwordx4 v[24:27], v3, s[44:45] nt
  s_add_u32 s44, s44, s61
  s_addc_u32 s45, s45, 0
  global_load_dwordx4 v[28:31], v3, s[44:45] nt
  s_add_u32 s44, s44, s61
  s_addc_u32 s45, s45, 0
  global_load_dwordx4 v[32:35], v3, s[44:45] nt
  s_add_u32 s44, s44, s61
  s_addc_u32 s45, s45, 0
  global_load_dwordx4 v[36:39], v3, s[44:45] nt
  s_add_u32 s44, s44, s61
  s_addc_u32 s45, s45, 0
  global_load_dwordx4 v[40:43], v3, s[44:45] nt
  s_add_u32 s44, s44, s61
  s_addc_u32 s45, s45, 0
  global_load_dwordx4 v[44:47], v3, s[44:45] nt
  s_add_u32 s44, s44, s61
  s_addc_u32 s45, s45, 0
  global_load_dwordx4 v[48:51], v3, s[44:45] nt
  s_add_u32 s44, s44, s61
  s_addc_u32 s45, s45, 0
  global_load_dwordx4 v[52:55], v3, s[44:45] nt
  s_add_u32 s44, s44, s61
  s_addc_u32 s45, s45, 0
  global_load_dwordx4 v[56:59], v3, s[44:45] nt
  s_add_u32 s44, s44, s61
  s_addc_u32 s45, s45, 0
  global_load_dwordx4 v[60:63], v3, s[44:45] nt
  s_add_u32 s44, s44, s61
  s_addc_u32 s45, s45, 0
  global_load_dwordx4 v[64:67], v3, s[44:45] nt
  s_add_u32 s44, s44, s61
  s_addc_u32 s45, s45, 0
  global_load_dwordx4 v[68:71], v3, s[44:45] nt
  s_add_u32 s44, s44, s61
  s_addc_u32 s45, s45, 0
  global_load_dwordx4 v[72:75], v3, s[44:45] nt
  s_add_u32 s44, s44, s61
  s_addc_u32 s45, s45, 0
  global_load_dwordx4 v[76:79], v3, s[44:45] nt
  s_waitcnt lgkmcnt(0)
  s_barrier
  s_and_b32 s58, s60, 63
  v_mov_b32 v148, -1
  v_mov_b32 v149, -1
  v_mov_b32 v150, -1
  v_mov_b32 v151, -1
  v_lshrrev_b32 v3, 5, v0
  s_lshl_b32 s46, s51, 2
  v_add_u32 v3, s46, v3
  s_movk_i32 s46, 14336
  v_mul_lo_u32 v184, v3, s46
  v_and_b32 v3, 31, v0
  v_lshl_add_u32 v184, v3, 4, v184
  s_lshl_b32 s46, s52, 9
  s_add_u32 s46, s46, 0x5e000
  v_add_u32 v184, s46, v184
  v_add_u32 v185, 28672, v184
  global_store_dwordx4 v184, v[148:151], s[34:35] sc1
  global_store_dwordx4 v185, v[148:151], s[34:35] sc1
  v_lshrrev_b32 v3, 3, v0
  v_lshlrev_b32 v3, 3, v3
  v_lshl_add_u32 v11, v15, 2, v3
  s_lshl_b32 s46, s57, 7
  v_add_u32 v146, s46, v14
  v_lshlrev_b32 v146, 13, v146
  s_lshl_b32 s46, s58, 7
  v_add3_u32 v146, v146, v15, s46
  s_lshl_b32 s46, s57, 8
  v_add_u32 v147, s46, v13
  v_lshlrev_b32 v14, 1, v14
  v_add_u32 v12, s56, v11
  s_branch L_chain_compute
L_tail_stream:
  global_load_dword v196, v1, s[34:35] offset:0 sc1
  s_and_b32 s46, s53, 3
  s_cmp_eq_u32 s46, 3
  s_cselect_b32 s75, 4, 8
  s_cmp_ge_u32 s53, 28
  s_cselect_b32 s75, 8, s75
  s_cselect_b32 s76, 7, 0
  s_cmp_lt_u32 s3, s75
  s_cselect_b32 s75, 1, 0
  s_cmp_lt_u32 s3, s76
  s_cselect_b32 s76, 1, 0
  s_lshl_b32 s77, s3, 2
  s_add_u32 s77, s77, 3
  s_sub_u32 s78, s53, 24
  s_cmp_eq_u32 s75, 0
  s_cbranch_scc1 L_t_noA
  s_lshr_b32 s46, s3, 1
  s_lshl_b32 s46, s46, 5
  s_and_b32 s54, s3, 1
  s_lshl_b32 s54, s54, 2
  s_add_u32 s46, s46, s54
  s_lshl_b32 s54, s53, 7
  s_add_u32 s46, s46, s54
  s_lshl_b32 s46, s46, 10
  v_add_u32 v3, s46, v2
  s_add_u32 s44, s16, 0
  s_addc_u32 s45, s17, 0
  global_load_dwordx4 v[16:19], v3, s[44:45] offset:0 nt
  s_add_u32 s44, s16, 8192
  s_addc_u32 s45, s17, 0
  global_load_dwordx4 v[20:23], v3, s[44:45] offset:0 nt
  s_add_u32 s44, s16, 16384
  s_addc_u32 s45, s17, 0
  global_load_dwordx4 v[24:27], v3, s[44:45] offset:0 nt
  s_add_u32 s44, s16, 24576
  s_addc_u32 s45, s17, 0
  global_load_dwordx4 v[28:31], v3, s[44:45] offset:0 nt
  s_add_u32 s44, s16, 0
  s_addc_u32 s45, s17, 0
  global_load_dwordx4 v[32:35], v3, s[44:45] offset:1024 nt
  s_add_u32 s44, s16, 8192
  s_addc_u32 s45, s17, 0
  global_load_dwordx4 v[36:39], v3, s[44:45] offset:1024 nt
  s_add_u32 s44, s16, 16384
  s_addc_u32 s45, s17, 0
  global_load_dwordx4 v[40:43], v3, s[44:45] offset:1024 nt
  s_add_u32 s44, s16, 24576
  s_addc_u32 s45, s17, 0
  global_load_dwordx4 v[44:47], v3, s[44:45] offset:1024 nt
  s_add_u32 s44, s16, 0
  s_addc_u32 s45, s17, 0
  global_load_dwordx4 v[48:51], v3, s[44:45] offset:2048 nt
  s_add_u32 s44, s16, 8192
  s_addc_u32 s45, s17, 0
  global_load_dwordx4 v[52:55], v3, s[44:45] offset:2048 nt
  s_add_u32 s44, s16, 16384
  s_addc_u32 s45, s17, 0
  global_load_dwordx4 v[56:59], v3, s[44:45] offset:2048 nt
  s_add_u32 s44, s16, 24576
  s_addc_u32 s45, s17, 0
  global_load_dwordx4 v[60:63], v3, s[44:45] offset:2048 nt
  s_add_u32 s44, s16, 0
  s_addc_u32 s45, s17, 0
  global_load_dwordx4 v[64:67], v3, s[44:45] offset:3072 nt
  s_add_u32 s44, s16, 8192
  s_addc_u32 s45, s17, 0
  global_load_dwordx4 v[68:71], v3, s[44:45] offset:3072 nt
  s_add_u32 s44, s16, 16384
  s_addc_u32 s45, s17, 0
  global_load_dwordx4 v[72:75], v3, s[44:45] offset:3072 nt
  s_add_u32 s44, s16, 24576
  s_addc_u32 s45, s17, 0
  global_load_dwordx4 v[76:79], v3, s[44:45] offset:3072 nt
L_t_noA:
  s_cmp_eq_u32 s76, 0
  s_cbranch_scc1 L_t_noB
  s_lshr_b32 s46, s78, 1
  s_lshl_b32 s46, s46, 5
  s_and_b32 s54, s78, 1
  s_lshl_b32 s54, s54, 2
  s_add_u32 s46, s46, s54
  s_lshl_b32 s54, s77, 7
  s_add_u32 s46, s46, s54
  s_lshl_b32 s46, s46, 10
  v_add_u32 v3, s46, v2
  s_add_u32 s44, s16, 0
  s_addc_u32 s45, s17, 0
  global_load_dwordx4 v[80:83], v3, s[44:45] offset:0 nt
  s_add_u32 s44, s16, 8192
  s_addc_u32 s45, s17, 0
  global_load_dwordx4 v[84:87], v3, s[44:45] offset:0 nt
  s_add_u32 s44, s16, 16384
  s_addc_u32 s45, s17, 0
  global_load_dwordx4 v[88:91], v3, s[44:45] offset:0 nt
  s_add_u32 s44, s16, 24576
  s_addc_u32 s45, s17, 0
  global_load_dwordx4 v[92:95], v3, s[44:45] offset:0 nt
  s_add_u32 s44, s16, 0
  s_addc_u32 s45, s17, 0
  global_load_dwordx4 v[96:99], v3, s[44:45] offset:1024 nt
  s_add_u32 s44, s16, 8192
  s_addc_u32 s45, s17, 0
  global_load_dwordx4 v[100:103], v3, s[44:45] offset:1024 nt
  s_add_u32 s44, s16, 16384
  s_addc_u32 s45, s17, 0
  global_load_dwordx4 v[104:107], v3, s[44:45] offset:1024 nt
  s_add_u32 s44, s16, 24576
  s_addc_u32 s45, s17, 0
  global_load_dwordx4 v[108:111], v3, s[44:45] offset:1024 nt
  s_add_u32 s44, s16, 0
  s_addc_u32 s45, s17, 0
  global_load_dwordx4 v[112:115], v3, s[44:45] offset:2048 nt
  s_add_u32 s44, s16, 8192
  s_addc_u32 s45, s17, 0
  global_load_dwordx4 v[116:119], v3, s[44:45] offset:2048 nt
  s_add_u32 s44, s16, 16384
  s_addc_u32 s45, s17, 0
  global_load_dwordx4 v[120:123], v3, s[44:45] offset:2048 nt
  s_add_u32 s44, s16, 24576
  s_addc_u32 s45, s17, 0
  global_load_dwordx4 v[124:127], v3, s[44:45] offset:2048 nt
  s_add_u32 s44, s16, 0
  s_addc_u32 s45, s17, 0
  global_load_dwordx4 v[128:131], v3, s[44:45] offset:3072 nt
  s_add_u32 s44, s16, 8192
  s_addc_u32 s45, s17, 0
  global_load_dwordx4 v[132:135], v3, s[44:45] offset:3072 nt
  s_add_u32 s44, s16, 16384
  s_addc_u32 s45, s17, 0
  global_load_dwordx4 v[136:139], v3, s[44:45] offset:3072 nt
  s_add_u32 s44, s16, 24576
  s_addc_u32 s45, s17, 0
  global_load_dwordx4 v[140:143], v3, s[44:45] offset:3072 nt
L_t_noB:
  s_cmp_lg_u32 s3, 0
  s_cbranch_scc1 L_t_noclr
  v_mov_b32 v200, -1
  v_mov_b32 v201, -1
  v_mov_b32 v202, -1
  v_mov_b32 v203, -1
  s_lshl_b32 s46, s53, 11
  v_add_u32 v14, s46, v2
  v_add_u32 v15, 0x3e000, v14
  global_store_dwordx4 v15, v[200:203], s[34:35] sc1
  global_store_dwordx4 v15, v[200:203], s[34:35] offset:1024 sc1
  v_add_u32 v15, 0x4e000, v14
  global_store_dwordx4 v15, v[200:203], s[34:35] sc1
  global_store_dwordx4 v15, v[200:203], s[34:35] offset:1024 sc1
  s_lshl_b32 s46, s53, 6
  s_add_u32 s46, s46, 0x3d000
  v_add_u32 v15, s46, v2
  s_mov_b64 exec, 15
  global_store_dwordx4 v15, v[200:203], s[34:35] sc1
  s_getreg_b32 s46, hwreg(HW_REG_XCC_ID)
  s_and_b32 s46, s46, 15
  s_add_u32 s46, s46, 1
  v_mov_b32 v15, s46
  v_mov_b32 v14, s53
  s_mov_b64 exec, 1
  s_waitcnt vmcnt(0)
  global_store_byte v14, v15, s[32:33] offset:128 sc1
  s_mov_b64 exec, -1
L_t_noclr:
  v_lshrrev_b32 v14, 2, v0
  v_and_b32 v15, 3, v0
  v_lshlrev_b32 v183, 9, v14
  v_lshl_add_u32 v183, v15, 4, v183
  s_mul_i32 s46, s53, 14336
  s_lshl_b32 s54, s3, 6
  s_add_u32 s46, s46, s54
  s_add_u32 s46, s46, 0x5e000
  s_mul_i32 s54, s77, 14336
  s_lshl_b32 s55, s78, 6
  s_add_u32 s54, s54, s55
  s_add_u32 s54, s54, 0x5e000
  v_add_u32 v4, s54, v183
  v_add_u32 v5, 0x2000, v4
  v_add_u32 v183, s46, v183
  v_add_u32 v184, 0x2000, v183
  s_lshl_b32 s46, s53, 9
  s_add_u32 s46, s46, 0x39000
  v_lshlrev_b32 v185, 4, v14
  s_lshl_b32 s54, s77, 9
  s_add_u32 s54, s54, 0x39000
  v_add_u32 v6, s54, v185
  v_add_u32 v185, s46, v185
  s_lshl_b32 s46, s53, 11
  v_add_u32 v186, s46, v2
  v_add_u32 v187, 0x3d000, v2
  v_lshlrev_b32 v14, 2, v0
  s_lshl_b32 s46, s3, 8
  v_add_u32 v14, s46, v14
  v_add_u32 v188, 0x3d000, v14
  v_lshlrev_b32 v14, 1, v14
  v_add_u32 v197, 0xa000, v14
  v_lshrrev_b32 v15, 5, v0
  v_lshlrev_b32 v189, 8, v15
  v_and_b32 v15, 7, v0
  v_lshl_add_u32 v189, v15, 5, v189
  v_bfe_u32 v15, v0, 3, 2
  v_lshl_add_u32 v189, v15, 3, v189
  s_lshl_b32 s46, s3, 9
  v_add_u32 v189, s46, v189
  v_lshrrev_b32 v15, 3, v0
  v_lshlrev_b32 v190, 9, v15
  v_and_b32 v15, 7, v0
  v_lshl_add_u32 v190, v15, 2, v190
  s_lshl_b32 s46, s3, 5
  v_add_u32 v190, s46, v190
  s_lshl_b32 s46, s3, 11
  v_lshlrev_b32 v194, 5, v0
  v_add_u32 v194, s46, v194
  s_lshl_b32 s46, s3, 10
  v_add_u32 v195, s46, v2
  s_lshl_b32 s46, s3, 6
  v_add_u32 v15, s46, v0
  v_lshrrev_b32 v191, 2, v15
  v_lshlrev_b32 v191, 11, v191
  v_and_b32 v15, 3, v15
  v_lshl_add_u32 v191, v15, 4, v191
  s_lshl_b32 s46, s53, 6
  v_add_u32 v191, s46, v191
  v_and_b32 v15, 3, v0
  v_lshlrev_b32 v192, 3, v15
  v_lshrrev_b32 v15, 5, v0
  v_lshl_add_u32 v192, v15, 2, v192
  s_lshl_b32 s46, s53, 5
  v_add_u32 v192, s46, v192
  global_load_dword v181, v192, s[8:9]
  v_bfe_u32 v15, v0, 4, 1
  v_lshlrev_b32 v15, 2, v15
  v_lshl_add_u32 v15, v192, 1, v15
  v_add_u32 v193, 0x3d000, v15
  v_lshlrev_b32 v15, 1, v15
  v_add_u32 v198, 0x9000, v15
  s_cmp_lg_u32 s3, 1
  s_cbranch_scc1 Ld_14
  s_mov_b64 s[6:7], 0
  s_mov_b64 exec, 0
  s_branch L_tail_compute
L_tail_dry_ret:
  s_mov_b64 s[6:7], -1
  s_mov_b64 exec, -1
Ld_14:
  s_cmp_ge_u32 s53, 28
  s_cbranch_scc1 L_t_ld_aux
  v_lshrrev_b32 v14, 3, v0
  v_lshlrev_b32 v14, 3, v14
  s_lshl_b32 s46, s3, 6
  v_add_u32 v14, s46, v14
  s_movk_i32 s46, 3584
  v_mul_lo_u32 v14, v14, s46
  v_and_b32 v3, 7, v0
  v_lshl_add_u32 v14, v3, 4, v14
  s_lshl_b32 s46, s53, 7
  v_add_u32 v14, s46, v14
  v_bfe_u32 v3, v0, 2, 1
  v_mul_u32_u24 v3, 14336, v3
  v_add_u32 v15, 14336, v14
  v_sub_u32 v15, v15, v3
  v_add_u32 v14, v14, v3
  s_waitcnt vmcnt(8)
  s_add_u32 s44, s20, 0
  s_addc_u32 s45, s21, 0
  global_load_dwordx4 v[80:83], v14, s[44:45] nt
  s_add_u32 s44, s20, 3584
  s_addc_u32 s45, s21, 0
  global_load_dwordx4 v[84:87], v14, s[44:45] nt
  s_add_u32 s44, s20, 7168
  s_addc_u32 s45, s21, 0
  global_load_dwordx4 v[88:91], v14, s[44:45] nt
  s_add_u32 s44, s20, 10752
  s_addc_u32 s45, s21, 0
  global_load_dwordx4 v[92:95], v14, s[44:45] nt
  s_waitcnt vmcnt(8)
  s_add_u32 s44, s20, 0
  s_addc_u32 s45, s21, 0
  global_load_dwordx4 v[96:99], v15, s[44:45] nt
  s_add_u32 s44, s20, 3584
  s_addc_u32 s45, s21, 0
  global_load_dwordx4 v[100:103], v15, s[44:45] nt
  s_add_u32 s44, s20, 7168
  s_addc_u32 s45, s21, 0
  global_load_dwordx4 v[104:107], v15, s[44:45] nt
  s_add_u32 s44, s20, 10752
  s_addc_u32 s45, s21, 0
  global_load_dwordx4 v[108:111], v15, s[44:45] nt
  s_waitcnt vmcnt(8)
  s_add_u32 s44, s22, 0
  s_addc_u32 s45, s23, 0
  global_load_dwordx4 v[112:115], v14, s[44:45] nt
  s_add_u32 s44, s22, 3584
  s_addc_u32 s45, s23, 0
  global_load_dwordx4 v[116:119], v14, s[44:45] nt
  s_add_u32 s44, s22, 7168
  s_addc_u32 s45, s23, 0
  global_load_dwordx4 v[120:123], v14, s[44:45] nt
  s_add_u32 s44, s22, 10752
  s_addc_u32 s45, s23, 0
  global_load_dwordx4 v[124:127], v14, s[44:45] nt
  s_waitcnt vmcnt(8)
  s_add_u32 s44, s22, 0
  s_addc_u32 s45, s23, 0
  global_load_dwordx4 v[128:131], v15, s[44:45] nt
  s_add_u32 s44, s22, 3584
  s_addc_u32 s45, s23, 0
  global_load_dwordx4 v[132:135], v15, s[44:45] nt
  s_add_u32 s44, s22, 7168
  s_addc_u32 s45, s23, 0
  global_load_dwordx4 v[136:139], v15, s[44:45] nt
  s_add_u32 s44, s22, 10752
  s_addc_u32 s45, s23, 0
  global_load_dwordx4 v[140:143], v15, s[44:45] nt
L_t_ld_aux:
  s_waitcnt vmcnt(8)
  s_add_u32 s44, s34, 0
  s_addc_u32 s45, s35, 0
  global_load_dwordx2 v[200:201], v197, s[44:45] sc1
  global_load_dwordx2 v[204:205], v198, s[44:45] sc1
  s_add_u32 s44, s44, 4096
  s_addc_u32 s45, s45, 0
  global_load_dwordx2 v[202:203], v197, s[44:45] sc1
  s_add_u32 s44, s44, 8192
  s_addc_u32 s45, s45, 0
  global_load_dwordx2 v[206:207], v198, s[44:45] sc1
  s_add_u32 s44, s34, 16384
  s_addc_u32 s45, s35, 0
  global_load_dwordx2 v[208:209], v197, s[44:45] sc1
  global_load_dwordx2 v[212:213], v198, s[44:45] sc1
  s_add_u32 s44, s44, 4096
  s_addc_u32 s45, s45, 0
  global_load_dwordx2 v[210:211], v197, s[44:45] sc1
  s_add_u32 s44, s44, 8192
  s_addc_u32 s45, s45, 0
  global_load_dwordx2 v[214:215], v198, s[44:45] sc1
  s_add_u32 s44, s34, 32768
  s_addc_u32 s45, s35, 0
  global_load_dwordx2 v[216:217], v197, s[44:45] sc1
  global_load_dwordx2 v[220:221], v198, s[44:45] sc1
  s_add_u32 s44, s44, 4096
  s_addc_u32 s45, s45, 0
  global_load_dwordx2 v[218:219], v197, s[44:45] sc1
  s_add_u32 s44, s44, 8192
  s_addc_u32 s45, s45, 0
  global_load_dwordx2 v[222:223], v198, s[44:45] sc1
  s_add_u32 s44, s34, 49152
  s_addc_u32 s45, s35, 0
  global_load_dwordx2 v[224:225], v197, s[44:45] sc1
  global_load_dwordx2 v[228:229], v198, s[44:45] sc1
  s_add_u32 s44, s44, 4096
  s_addc_u32 s45, s45, 0
  global_load_dwordx2 v[226:227], v197, s[44:45] sc1
  s_add_u32 s44, s44, 8192
  s_addc_u32 s45, s45, 0
  global_load_dwordx2 v[230:231], v198, s[44:45] sc1
  v_and_b32 v14, 31, v0
  global_load_ubyte v232, v14, s[32:33] offset:128 sc1
  s_cmp_ge_u32 s53, 28
  s_cbranch_scc1 L_t_nodn
  s_lshl_b32 s46, s53, 6
  s_lshl_b32 s54, s3, 3
  s_add_u32 s46, s46, s54
  s_lshl_b32 s46, s46, 10
  v_add_u32 v3, s46, v2
  s_add_u32 s44, s24, 0
  s_addc_u32 s45, s25, 0
  global_load_dwordx4 v[144:147], v3, s[44:45] offset:0 nt
  s_add_u32 s44, s24, 0
  s_addc_u32 s45, s25, 0
  global_load_dwordx4 v[148:151], v3, s[44:45] offset:1024 nt
  s_add_u32 s44, s24, 0
  s_addc_u32 s45, s25, 0
  global_load_dwordx4 v[152:155], v3, s[44:45] offset:2048 nt
  s_add_u32 s44, s24, 0
  s_addc_u32 s45, s25, 0
  global_load_dwordx4 v[156:159], v3, s[44:45] offset:3072 nt
  s_add_u32 s44, s24, 4096
  s_addc_u32 s45, s25, 0
  global_load_dwordx4 v[160:163], v3, s[44:45] offset:0 nt
  s_add_u32 s44, s24, 4096
  s_addc_u32 s45, s25, 0
  global_load_dwordx4 v[164:167], v3, s[44:45] offset:1024 nt
  s_add_u32 s44, s24, 4096
  s_addc_u32 s45, s25, 0
  global_load_dwordx4 v[168:171], v3, s[44:45] offset:2048 nt
  s_add_u32 s44, s24, 4096
  s_addc_u32 s45, s25, 0
  global_load_dwordx4 v[172:175], v3, s[44:45] offset:3072 nt
  s_waitcnt vmcnt(25)
  s_branch L_t_il1
L_t_nodn:
  s_waitcnt vmcnt(17)
L_t_il1:
  v_add_u32 v196, 0x9e3779b9, v196
  v_perm_b32 v176, v20, v16, s48
  v_perm_b32 v20, v20, v16, s49
  v_perm_b32 v16, v21, v17, s48
  v_perm_b32 v21, v21, v17, s49
  v_perm_b32 v17, v22, v18, s48
  v_perm_b32 v22, v22, v18, s49
  v_perm_b32 v18, v23, v19, s48
  v_perm_b32 v23, v23, v19, s49
  v_perm_b32 v19, v28, v24, s48
  v_perm_b32 v28, v28, v24, s49
  v_perm_b32 v24, v29, v25, s48
  v_perm_b32 v29, v29, v25, s49
  v_perm_b32 v25, v30, v26, s48
  v_perm_b32 v30, v30, v26, s49
  v_perm_b32 v26, v31, v27, s48
  v_perm_b32 v31, v31, v27, s49
  v_perm_b32 v27, v36, v32, s48
  v_perm_b32 v36, v36, v32, s49
  v_perm_b32 v32, v37, v33, s48
  v_perm_b32 v37, v37, v33, s49
  v_perm_b32 v33, v38, v34, s48
  v_perm_b32 v38, v38, v34, s49
  v_perm_b32 v34, v39, v35, s48
  v_perm_b32 v39, v39, v35, s49
  v_perm_b32 v35, v44, v40, s48
  v_perm_b32 v44, v44, v40, s49
  v_perm_b32 v40, v45, v41, s48
  v_perm_b32 v45, v45, v41, s49
  v_perm_b32 v41, v46, v42, s48
  v_perm_b32 v46, v46, v42, s49
  v_perm_b32 v42, v47, v43, s48
  v_perm_b32 v47, v47, v43, s49
  v_perm_b32 v43, v52, v48, s48
  v_perm_b32 v52, v52, v48, s49
  v_perm_b32 v48, v53, v49, s48
  v_perm_b32 v53, v53, v49, s49
  v_perm_b32 v49, v54, v50, s48
  v_perm_b32 v54, v54, v50, s49
  v_perm_b32 v50, v55, v51, s48
  v_perm_b32 v55, v55, v51, s49
  v_perm_b32 v51, v60, v56, s48
  v_perm_b32 v60, v60, v56, s49
  v_perm_b32 v56, v61, v57, s48
  v_perm_b32 v61, v61, v57, s49
  v_perm_b32 v57, v62, v58, s48
  v_perm_b32 v62, v62, v58, s49
  v_perm_b32 v58, v63, v59, s48
  v_perm_b32 v63, v63, v59, s49
  v_perm_b32 v59, v68, v64, s48
  v_perm_b32 v68, v68, v64, s49
  v_perm_b32 v64, v69, v65, s48
  v_perm_b32 v69, v69, v65, s49
  v_perm_b32 v65, v70, v66, s48
  v_perm_b32 v70, v70, v66, s49
  v_perm_b32 v66, v71, v67, s48
  v_perm_b32 v71, v71, v67, s49
  v_perm_b32 v67, v76, v72, s48
  v_perm_b32 v76, v76, v72, s49
  v_perm_b32 v72, v77, v73, s48
  v_perm_b32 v77, v77, v73, s49
  v_perm_b32 v73, v78, v74, s48
  v_perm_b32 v78, v78, v74, s49
  v_perm_b32 v74, v79, v75, s48
  v_perm_b32 v79, v79, v75, s49
  v_perm_b32 v75, v84, v80, s48
  v_perm_b32 v84, v84, v80, s49
  v_perm_b32 v80, v85, v81, s48
  v_perm_b32 v85, v85, v81, s49
  v_perm_b32 v81, v86, v82, s48
  v_perm_b32 v86, v86, v82, s49
  v_perm_b32 v82, v87, v83, s48
  v_perm_b32 v87, v87, v83, s49
  v_perm_b32 v83, v92, v88, s48
  v_perm_b32 v92, v92, v88, s49
  v_perm_b32 v88, v93, v89, s48
  v_perm_b32 v93, v93, v89, s49
  v_perm_b32 v89, v94, v90, s48
  v_perm_b32 v94, v94, v90, s49
  v_perm_b32 v90, v95, v91, s48
  v_perm_b32 v95, v95, v91, s49
  v_perm_b32 v91, v100, v96, s48
  v_perm_b32 v100, v100, v96, s49
  v_perm_b32 v96, v101, v97, s48
  v_perm_b32 v101, v101, v97, s49
  v_perm_b32 v97, v102, v98, s48
  v_perm_b32 v102, v102, v98, s49
  v_perm_b32 v98, v103, v99, s48
  v_perm_b32 v103, v103, v99, s49
  v_perm_b32 v99, v108, v104, s48
  v_perm_b32 v108, v108, v104, s49
  v_perm_b32 v104, v109, v105, s48
  v_perm_b32 v109, v109, v105, s49
  v_perm_b32 v105, v110, v106, s48
  v_perm_b32 v110, v110, v106, s49
  v_perm_b32 v106, v111, v107, s48
  v_perm_b32 v111, v111, v107, s49
  v_perm_b32 v107, v116, v112, s48
  v_perm_b32 v116, v116, v112, s49
  v_perm_b32 v112, v117, v113, s48
  v_perm_b32 v117, v117, v113, s49
  v_perm_b32 v113, v118, v114, s48
  v_perm_b32 v118, v118, v114, s49
  v_perm_b32 v114, v119, v115, s48
  v_perm_b32 v119, v119, v115, s49
  v_perm_b32 v115, v124, v120, s48
  v_perm_b32 v124, v124, v120, s49
  v_perm_b32 v120, v125, v121, s48
  v_perm_b32 v125, v125, v121, s49
  v_perm_b32 v121, v126, v122, s48
  v_perm_b32 v126, v126, v122, s49
  v_perm_b32 v122, v127, v123, s48
  v_perm_b32 v127, v127, v123, s49
  v_perm_b32 v123, v132, v128, s48
  v_perm_b32 v132, v132, v128, s49
  v_perm_b32 v128, v133, v129, s48
  v_perm_b32 v133, v133, v129, s49
  v_perm_b32 v129, v134, v130, s48
  v_perm_b32 v134, v134, v130, s49
  v_perm_b32 v130, v135, v131, s48
  v_perm_b32 v135, v135, v131, s49
  v_perm_b32 v131, v140, v136, s48
  v_perm_b32 v140, v140, v136, s49
  v_perm_b32 v136, v141, v137, s48
  v_perm_b32 v141, v141, v137, s49
  v_perm_b32 v137, v142, v138, s48
  v_perm_b32 v142, v142, v138, s49
  v_perm_b32 v138, v143, v139, s48
  v_perm_b32 v143, v143, v139, s49
  v_readfirstlane_b32 s59, v196
  s_mov_b32 s63, 262144
  s_cmp_ge_u32 s53, 28
  s_cbranch_scc1 L_t_aux_w0
  s_waitcnt vmcnt(8)
  s_branch L_t_aux_chk
  s_mov_b32 s63, 262144
Lp_15:
  s_sub_u32 s63, s63, 1
  s_cbranch_scc1 Lq_16
  s_sleep 8
  s_add_u32 s44, s34, 0
  s_addc_u32 s45, s35, 0
  global_load_dwordx2 v[200:201], v197, s[44:45] sc1
  global_load_dwordx2 v[204:205], v198, s[44:45] sc1
  s_add_u32 s44, s44, 4096
  s_addc_u32 s45, s45, 0
  global_load_dwordx2 v[202:203], v197, s[44:45] sc1
  s_add_u32 s44, s44, 8192
  s_addc_u32 s45, s45, 0
  global_load_dwordx2 v[206:207], v198, s[44:45] sc1
  s_add_u32 s44, s34, 16384
  s_addc_u32 s45, s35, 0
  global_load_dwordx2 v[208:209], v197, s[44:45] sc1
  global_load_dwordx2 v[212:213], v198, s[44:45] sc1
  s_add_u32 s44, s44, 4096
  s_addc_u32 s45, s45, 0
  global_load_dwordx2 v[210:211], v197, s[44:45] sc1
  s_add_u32 s44, s44, 8192
  s_addc_u32 s45, s45, 0
  global_load_dwordx2 v[214:215], v198, s[44:45] sc1
  s_add_u32 s44, s34, 32768
  s_addc_u32 s45, s35, 0
  global_load_dwordx2 v[216:217], v197, s[44:45] sc1
  global_load_dwordx2 v[220:221], v198, s[44:45] sc1
  s_add_u32 s44, s44, 4096
  s_addc_u32 s45, s45, 0
  global_load_dwordx2 v[218:219], v197, s[44:45] sc1
  s_add_u32 s44, s44, 8192
  s_addc_u32 s45, s45, 0
  global_load_dwordx2 v[222:223], v198, s[44:45] sc1
  s_add_u32 s44, s34, 49152
  s_addc_u32 s45, s35, 0
  global_load_dwordx2 v[224:225], v197, s[44:45] sc1
  global_load_dwordx2 v[228:229], v198, s[44:45] sc1
  s_add_u32 s44, s44, 4096
  s_addc_u32 s45, s45, 0
  global_load_dwordx2 v[226:227], v197, s[44:45] sc1
  s_add_u32 s44, s44, 8192
  s_addc_u32 s45, s45, 0
  global_load_dwordx2 v[230:231], v198, s[44:45] sc1
  v_and_b32 v14, 31, v0
  global_load_ubyte v232, v14, s[32:33] offset:128 sc1
L_t_aux_w0:
  s_waitcnt vmcnt(0)
L_t_aux_chk:
  v_min3_u32 v234, v201, v203, v205
  v_min3_u32 v234, v234, v207, v209
  v_min3_u32 v234, v234, v211, v213
  v_min3_u32 v234, v234, v215, v217
  v_min3_u32 v234, v234, v219, v221
  v_min3_u32 v234, v234, v223, v225
  v_min3_u32 v234, v234, v227, v229
  v_min_u32 v234, v234, v231
  v_max3_u32 v235, v201, v203, v205
  v_max3_u32 v235, v235, v207, v209
  v_max3_u32 v235, v235, v211, v213
  v_max3_u32 v235, v235, v215, v217
  v_max3_u32 v235, v235, v219, v221
  v_max3_u32 v235, v235, v223, v225
  v_max3_u32 v235, v235, v227, v229
  v_max_u32 v235, v235, v231
  v_cmp_ne_u32 vcc, s59, v234
  v_cmp_ne_u32 s[44:45], s59, v235
  s_nop 0
  s_or_b64 vcc, vcc, s[44:45]
  v_cmp_eq_u32 s[44:45], 0, v232
  s_nop 0
  s_or_b64 vcc, vcc, s[44:45]
  s_cbranch_vccnz Lp_15
Lq_16:
  s_getreg_b32 s46, hwreg(HW_REG_XCC_ID)
  s_and_b32 s46, s46, 15
  s_add_u32 s46, s46, 1
  v_cmp_ne_u32 vcc, s46, v232
  s_nop 0
  s_cmp_eq_u64 vcc, 0
  s_cselect_b32 s62, 1, 0
  v_add_f32 v200, v200, v208
  v_add_f32 v216, v216, v224
  v_add_f32 v200, v200, v216
  v_cvt_pk_bf16_f32 v178, v200, v200
  v_lshlrev_b32 v178, 16, v178
  v_add_f32 v202, v202, v210
  v_add_f32 v218, v218, v226
  v_add_f32 v202, v202, v218
  v_cvt_pk_bf16_f32 v177, v202, v202
  v_lshlrev_b32 v177, 16, v177
  v_add_f32 v204, v204, v212
  v_add_f32 v220, v220, v228
  v_add_f32 v204, v204, v220
  v_cvt_pk_bf16_f32 v179, v204, v204
  v_lshlrev_b32 v179, 16, v179
  v_add_f32 v206, v206, v214
  v_add_f32 v222, v222, v230
  v_add_f32 v206, v206, v222
  v_cvt_pk_bf16_f32 v180, v206, v206
  v_lshlrev_b32 v180, 16, v180
  v_add_f32 v177, 1.0, v177
  v_cvt_pk_bf16_f32 v177, v177, v177
  v_lshlrev_b32 v177, 16, v177
  v_bfe_u32 v15, v0, 4, 1
  v_lshlrev_b32 v15, 4, v15
  v_lshrrev_b32 v181, v15, v181
  v_lshlrev_b32 v181, 16, v181
  s_cmp_ge_u32 s53, 28
  s_cbranch_scc1 L_t_nopre
  v_mov_b32_dpp v232, v177 quad_perm:[1,1,3,3] row_mask:0xf bank_mask:0xf
  v_cvt_pk_bf16_f32 v232, v177, v232
  s_nop 1
  v_mov_b32_dpp v200, v232 quad_perm:[0,0,0,0] row_mask:0xf bank_mask:0xf
  v_mov_b32_dpp v201, v232 quad_perm:[2,2,2,2] row_mask:0xf bank_mask:0xf
  s_nop 0
  v_mov_b32_dpp v202, v200 row_half_mirror row_mask:0xf bank_mask:0xf
  v_mov_b32_dpp v203, v201 row_half_mirror row_mask:0xf bank_mask:0xf
  v_dot2_f32_bf16 v216, v75, v200, 0
  v_dot2_f32_bf16 v217, v84, v200, 0
  v_dot2_f32_bf16 v218, v80, v200, 0
  v_dot2_f32_bf16 v219, v85, v200, 0
  v_dot2_f32_bf16 v220, v81, v200, 0
  v_dot2_f32_bf16 v221, v86, v200, 0
  v_dot2_f32_bf16 v222, v82, v200, 0
  v_dot2_f32_bf16 v223, v87, v200, 0
  v_dot2_f32_bf16 v224, v107, v200, 0
  v_dot2_f32_bf16 v225, v116, v200, 0
  v_dot2_f32_bf16 v226, v112, v200, 0
  v_dot2_f32_bf16 v227, v117, v200, 0
  v_dot2_f32_bf16 v228, v113, v200, 0
  v_dot2_f32_bf16 v229, v118, v200, 0
  v_dot2_f32_bf16 v230, v114, v200, 0
  v_dot2_f32_bf16 v231, v119, v200, 0
  v_dot2_f32_bf16 v216, v83, v201, v216
  v_dot2_f32_bf16 v217, v92, v201, v217
  v_dot2_f32_bf16 v218, v88, v201, v218
  v_dot2_f32_bf16 v219, v93, v201, v219
  v_dot2_f32_bf16 v220, v89, v201, v220
  v_dot2_f32_bf16 v221, v94, v201, v221
  v_dot2_f32_bf16 v222, v90, v201, v222
  v_dot2_f32_bf16 v223, v95, v201, v223
  v_dot2_f32_bf16 v224, v115, v201, v224
  v_dot2_f32_bf16 v225, v124, v201, v225
  v_dot2_f32_bf16 v226, v120, v201, v226
  v_dot2_f32_bf16 v227, v125, v201, v227
  v_dot2_f32_bf16 v228, v121, v201, v228
  v_dot2_f32_bf16 v229, v126, v201, v229
  v_dot2_f32_bf16 v230, v122, v201, v230
  v_dot2_f32_bf16 v231, v127, v201, v231
  v_dot2_f32_bf16 v216, v91, v202, v216
  v_dot2_f32_bf16 v217, v100, v202, v217
  v_dot2_f32_bf16 v218, v96, v202, v218
  v_dot2_f32_bf16 v219, v101, v202, v219
  v_dot2_f32_bf16 v220, v97, v202, v220
  v_dot2_f32_bf16 v221, v102, v202, v221
  v_dot2_f32_bf16 v222, v98, v202, v222
  v_dot2_f32_bf16 v223, v103, v202, v223
  v_dot2_f32_bf16 v224, v123, v202, v224
  v_dot2_f32_bf16 v225, v132, v202, v225
  v_dot2_f32_bf16 v226, v128, v202, v226
  v_dot2_f32_bf16 v227, v133, v202, v227
  v_dot2_f32_bf16 v228, v129, v202, v228
  v_dot2_f32_bf16 v229, v134, v202, v229
  v_dot2_f32_bf16 v230, v130, v202, v230
  v_dot2_f32_bf16 v231, v135, v202, v231
  v_dot2_f32_bf16 v216, v99, v203, v216
  v_dot2_f32_bf16 v217, v108, v203, v217
  v_dot2_f32_bf16 v218, v104, v203, v218
  v_dot2_f32_bf16 v219, v109, v203, v219
  v_dot2_f32_bf16 v220, v105, v203, v220
  v_dot2_f32_bf16 v221, v110, v203, v221
  v_dot2_f32_bf16 v222, v106, v203, v222
  v_dot2_f32_bf16 v223, v111, v203, v223
  v_dot2_f32_bf16 v224, v131, v203, v224
  v_dot2_f32_bf16 v225, v140, v203, v225
  v_dot2_f32_bf16 v226, v136, v203, v226
  v_dot2_f32_bf16 v227, v141, v203, v227
  v_dot2_f32_bf16 v228, v137, v203, v228
  v_dot2_f32_bf16 v229, v142, v203, v229
  v_dot2_f32_bf16 v230, v138, v203, v230
  v_dot2_f32_bf16 v231, v143, v203, v231
  v_permlane32_swap_b32 v216, v224
  v_permlane32_swap_b32 v217, v225
  v_permlane32_swap_b32 v218, v226
  v_permlane32_swap_b32 v219, v227
  v_permlane32_swap_b32 v220, v228
  v_permlane32_swap_b32 v221, v229
  v_permlane32_swap_b32 v222, v230
  v_permlane32_swap_b32 v223, v231
  v_add_f32 v216, v216, v224
  v_add_f32 v217, v217, v225
  v_add_f32 v218, v218, v226
  v_add_f32 v219, v219, v227
  v_add_f32 v220, v220, v228
  v_add_f32 v221, v221, v229
  v_add_f32 v222, v222, v230
  v_add_f32 v223, v223, v231
  v_permlane16_swap_b32 v216, v220
  v_permlane16_swap_b32 v217, v221
  v_permlane16_swap_b32 v218, v222
  v_permlane16_swap_b32 v219, v223
  v_add_f32 v216, v216, v220
  v_add_f32 v217, v217, v221
  v_add_f32 v218, v218, v222
  v_add_f32 v219, v219, v223
  v_add_f32_dpp v232, v216, v216 row_ror:8 row_mask:0xf bank_mask:0x3
  v_add_f32_dpp v232, v218, v218 row_ror:8 row_mask:0xf bank_mask:0xc
  v_add_f32_dpp v233, v217, v217 row_ror:8 row_mask:0xf bank_mask:0x3
  v_add_f32_dpp v233, v219, v219 row_ror:8 row_mask:0xf bank_mask:0xc
  ds_write_b64 v189, v[232:233] offset:22528
  v_mov_b32_dpp v232, v178 quad_perm:[1,1,3,3] row_mask:0xf bank_mask:0xf
  v_cvt_pk_bf16_f32 v232, v178, v232
  s_nop 1
  v_mov_b32_dpp v200, v232 quad_perm:[0,0,0,0] row_mask:0xf bank_mask:0xf
  v_mov_b32_dpp v201, v232 quad_perm:[2,2,2,2] row_mask:0xf bank_mask:0xf
  s_nop 0
  v_mov_b32_dpp v202, v200 row_half_mirror row_mask:0xf bank_mask:0xf
  v_mov_b32_dpp v203, v201 row_half_mirror row_mask:0xf bank_mask:0xf
  v_dot2_f32_bf16 v216, v75, v200, 0
  v_dot2_f32_bf16 v217, v84, v200, 0
  v_dot2_f32_bf16 v218, v80, v200, 0
  v_dot2_f32_bf16 v219, v85, v200, 0
  v_dot2_f32_bf16 v220, v81, v200, 0
  v_dot2_f32_bf16 v221, v86, v200, 0
  v_dot2_f32_bf16 v222, v82, v200, 0
  v_dot2_f32_bf16 v223, v87, v200, 0
  v_dot2_f32_bf16 v224, v107, v200, 0
  v_dot2_f32_bf16 v225, v116, v200, 0
  v_dot2_f32_bf16 v226, v112, v200, 0
  v_dot2_f32_bf16 v227, v117, v200, 0
  v_dot2_f32_bf16 v228, v113, v200, 0
  v_dot2_f32_bf16 v229, v118, v200, 0
  v_dot2_f32_bf16 v230, v114, v200, 0
  v_dot2_f32_bf16 v231, v119, v200, 0
  v_dot2_f32_bf16 v216, v83, v201, v216
  v_dot2_f32_bf16 v217, v92, v201, v217
  v_dot2_f32_bf16 v218, v88, v201, v218
  v_dot2_f32_bf16 v219, v93, v201, v219
  v_dot2_f32_bf16 v220, v89, v201, v220
  v_dot2_f32_bf16 v221, v94, v201, v221
  v_dot2_f32_bf16 v222, v90, v201, v222
  v_dot2_f32_bf16 v223, v95, v201, v223
  v_dot2_f32_bf16 v224, v115, v201, v224
  v_dot2_f32_bf16 v225, v124, v201, v225
  v_dot2_f32_bf16 v226, v120, v201, v226
  v_dot2_f32_bf16 v227, v125, v201, v227
  v_dot2_f32_bf16 v228, v121, v201, v228
  v_dot2_f32_bf16 v229, v126, v201, v229
  v_dot2_f32_bf16 v230, v122, v201, v230
  v_dot2_f32_bf16 v231, v127, v201, v231
  v_dot2_f32_bf16 v216, v91, v202, v216
  v_dot2_f32_bf16 v217, v100, v202, v217
  v_dot2_f32_bf16 v218, v96, v202, v218
  v_dot2_f32_bf16 v219, v101, v202, v219
  v_dot2_f32_bf16 v220, v97, v202, v220
  v_dot2_f32_bf16 v221, v102, v202, v221
  v_dot2_f32_bf16 v222, v98, v202, v222
  v_dot2_f32_bf16 v223, v103, v202, v223
  v_dot2_f32_bf16 v224, v123, v202, v224
  v_dot2_f32_bf16 v225, v132, v202, v225
  v_dot2_f32_bf16 v226, v128, v202, v226
  v_dot2_f32_bf16 v227, v133, v202, v227
  v_dot2_f32_bf16 v228, v129, v202, v228
  v_dot2_f32_bf16 v229, v134, v202, v229
  v_dot2_f32_bf16 v230, v130, v202, v230
  v_dot2_f32_bf16 v231, v135, v202, v231
  v_dot2_f32_bf16 v216, v99, v203, v216
  v_dot2_f32_bf16 v217, v108, v203, v217
  v_dot2_f32_bf16 v218, v104, v203, v218
  v_dot2_f32_bf16 v219, v109, v203, v219
  v_dot2_f32_bf16 v220, v105, v203, v220
  v_dot2_f32_bf16 v221, v110, v203, v221
  v_dot2_f32_bf16 v222, v106, v203, v222
  v_dot2_f32_bf16 v223, v111, v203, v223
  v_dot2_f32_bf16 v224, v131, v203, v224
  v_dot2_f32_bf16 v225, v140, v203, v225
  v_dot2_f32_bf16 v226, v136, v203, v226
  v_dot2_f32_bf16 v227, v141, v203, v227
  v_dot2_f32_bf16 v228, v137, v203, v228
  v_dot2_f32_bf16 v229, v142, v203, v229
  v_dot2_f32_bf16 v230, v138, v203, v230
  v_dot2_f32_bf16 v231, v143, v203, v231
  v_permlane32_swap_b32 v216, v224
  v_permlane32_swap_b32 v217, v225
  v_permlane32_swap_b32 v218, v226
  v_permlane32_swap_b32 v219, v227
  v_permlane32_swap_b32 v220, v228
  v_permlane32_swap_b32 v221, v229
  v_permlane32_swap_b32 v222, v230
  v_permlane32_swap_b32 v223, v231
  v_add_f32 v216, v216, v224
  v_add_f32 v217, v217, v225
  v_add_f32 v218, v218, v226
  v_add_f32 v219, v219, v227
  v_add_f32 v220, v220, v228
  v_add_f32 v221, v221, v229
  v_add_f32 v222, v222, v230
  v_add_f32 v223, v223, v231
  v_permlane16_swap_b32 v216, v220
  v_permlane16_swap_b32 v217, v221
  v_permlane16_swap_b32 v218, v222
  v_permlane16_swap_b32 v219, v223
  v_add_f32 v216, v216, v220
  v_add_f32 v217, v217, v221
  v_add_f32 v218, v218, v222
  v_add_f32 v219, v219, v223
  v_add_f32_dpp v232, v216, v216 row_ror:8 row_mask:0xf bank_mask:0x3
  v_add_f32_dpp v232, v218, v218 row_ror:8 row_mask:0xf bank_mask:0xc
  v_add_f32_dpp v233, v217, v217 row_ror:8 row_mask:0xf bank_mask:0x3
  v_add_f32_dpp v233, v219, v219 row_ror:8 row_mask:0xf bank_mask:0xc
  ds_write_b64 v189, v[232:233] offset:26624
  s_waitcnt lgkmcnt(0)
  s_barrier
  ds_read_b32 v12, v190 offset:22528
  ds_read_b32 v232, v190 offset:22784
  s_waitcnt lgkmcnt(0)
  v_permlane32_swap_b32 v12, v232
  v_add_f32 v12, v12, v232
  v_mov_b32 v233, v12
  s_nop 1
  v_permlane16_swap_b32 v12, v233
  v_add_f32 v12, v12, v233
  s_nop 1
  v_add_f32_dpp v12, v12, v12 row_ror:8 row_mask:0xf bank_mask:0xf
  ds_read_b32 v13, v190 offset:26624
  ds_read_b32 v232, v190 offset:26880
  s_waitcnt lgkmcnt(0)
  v_permlane32_swap_b32 v13, v232
  v_add_f32 v13, v13, v232
  v_mov_b32 v233, v13
  s_nop 1
  v_permlane16_swap_b32 v13, v233
  v_add_f32 v13, v13, v233
  s_nop 1
  v_add_f32_dpp v13, v13, v13 row_ror:8 row_mask:0xf bank_mask:0xf
  s_waitcnt vmcnt(0)
  v_perm_b32 v139, v148, v144, s48
  v_perm_b32 v148, v148, v144, s49
  v_perm_b32 v144, v149, v145, s48
  v_perm_b32 v149, v149, v145, s49
  v_perm_b32 v145, v150, v146, s48
  v_perm_b32 v150, v150, v146, s49
  v_perm_b32 v146, v151, v147, s48
  v_perm_b32 v151, v151, v147, s49
  v_perm_b32 v147, v156, v152, s48
  v_perm_b32 v156, v156, v152, s49
  v_perm_b32 v152, v157, v153, s48
  v_perm_b32 v157, v157, v153, s49
  v_perm_b32 v153, v158, v154, s48
  v_perm_b32 v158, v158, v154, s49
  v_perm_b32 v154, v159, v155, s48
  v_perm_b32 v159, v159, v155, s49
  v_perm_b32 v155, v164, v160, s48
  v_perm_b32 v164, v164, v160, s49
  v_perm_b32 v160, v165, v161, s48
  v_perm_b32 v165, v165, v161, s49
  v_perm_b32 v161, v166, v162, s48
  v_perm_b32 v166, v166, v162, s49
  v_perm_b32 v162, v167, v163, s48
  v_perm_b32 v167, v167, v163, s49
  v_perm_b32 v163, v172, v168, s48
  v_perm_b32 v172, v172, v168, s49
  v_perm_b32 v168, v173, v169, s48
  v_perm_b32 v173, v173, v169, s49
  v_perm_b32 v169, v174, v170, s48
  v_perm_b32 v174, v174, v170, s49
  v_perm_b32 v170, v175, v171, s48
  v_perm_b32 v175, v175, v171, s49
  s_nop 1
L_t_nopre:
  s_branch L_tail_compute
.p2align 6
L_att_kphase:
  v_and_b32 v14, 3, v0
  v_lshlrev_b32 v14, 8, v14
  v_lshrrev_b32 v15, 2, v0
  v_lshl_add_u32 v14, v15, 4, v14
  ds_read_b128 v[4:7], v14 offset:512
  s_waitcnt lgkmcnt(0)
  v_mfma_f32_16x16x32_bf16 v[32:35], v[64:67], v[4:7], 0
  v_mfma_f32_16x16x32_bf16 v[36:39], v[68:71], v[4:7], 0
  v_mfma_f32_16x16x32_bf16 v[40:43], v[72:75], v[4:7], 0
  v_mfma_f32_16x16x32_bf16 v[44:47], v[76:79], v[4:7], 0
  v_mfma_f32_16x16x32_bf16 v[48:51], v[80:83], v[4:7], 0
  v_mfma_f32_16x16x32_bf16 v[52:55], v[84:87], v[4:7], 0
  v_mfma_f32_16x16x32_bf16 v[56:59], v[88:91], v[4:7], 0
  v_mfma_f32_16x16x32_bf16 v[60:63], v[92:95], v[4:7], 0
  s_nop 0
  v_mov_b32_dpp v8, v32 quad_perm:[0,1,2,3] row_mask:0xf bank_mask:0x1
  v_mov_b32_dpp v8, v37 quad_perm:[0,1,2,3] row_mask:0xf bank_mask:0x2
  v_mov_b32_dpp v8, v42 quad_perm:[0,1,2,3] row_mask:0xf bank_mask:0x4
  v_mov_b32_dpp v8, v47 quad_perm:[0,1,2,3] row_mask:0xf bank_mask:0x8
  v_add_f32_dpp v8, v33, v8 row_ror:12 row_mask:0xf bank_mask:0x1
  v_add_f32_dpp v8, v38, v8 row_ror:12 row_mask:0xf bank_mask:0x2
  v_add_f32_dpp v8, v43, v8 row_ror:12 row_mask:0xf bank_mask:0x4
  v_add_f32_dpp v8, v44, v8 row_ror:12 row_mask:0xf bank_mask:0x8
  v_add_f32_dpp v8, v34, v8 row_ror:8 row_mask:0xf bank_mask:0x1
  v_add_f32_dpp v8, v39, v8 row_ror:8 row_mask:0xf bank_mask:0x2
  v_add_f32_dpp v8, v40, v8 row_ror:8 row_mask:0xf bank_mask:0x4
  v_add_f32_dpp v8, v45, v8 row_ror:8 row_mask:0xf bank_mask:0x8
  v_add_f32_dpp v8, v35, v8 row_ror:4 row_mask:0xf bank_mask:0x1
  v_add_f32_dpp v8, v36, v8 row_ror:4 row_mask:0xf bank_mask:0x2
  v_add_f32_dpp v8, v41, v8 row_ror:4 row_mask:0xf bank_mask:0x4
  v_add_f32_dpp v8, v46, v8 row_ror:4 row_mask:0xf bank_mask:0x8
  v_cvt_pk_bf16_f32 v8, v8, v8
  v_lshlrev_b32 v8, 16, v8
  v_mul_f32 v8, 0x3db504f3, v8
  v_cvt_pk_bf16_f32 v8, v8, v8
  v_lshlrev_b32 v8, 16, v8
  v_mfma_f32_16x16x32_bf16 v[32:35], v[96:99], v[4:7], 0
  v_mfma_f32_16x16x32_bf16 v[36:39], v[100:103], v[4:7], 0
  v_mfma_f32_16x16x32_bf16 v[40:43], v[104:107], v[4:7], 0
  v_mfma_f32_16x16x32_bf16 v[44:47], v[108:111], v[4:7], 0
  v_mov_b32_dpp v9, v48 quad_perm:[0,1,2,3] row_mask:0xf bank_mask:0x1
  v_mov_b32_dpp v9, v53 quad_perm:[0,1,2,3] row_mask:0xf bank_mask:0x2
  v_mov_b32_dpp v9, v58 quad_perm:[0,1,2,3] row_mask:0xf bank_mask:0x4
  v_mov_b32_dpp v9, v63 quad_perm:[0,1,2,3] row_mask:0xf bank_mask:0x8
  v_add_f32_dpp v9, v49, v9 row_ror:12 row_mask:0xf bank_mask:0x1
  v_add_f32_dpp v9, v54, v9 row_ror:12 row_mask:0xf bank_mask:0x2
  v_add_f32_dpp v9, v59, v9 row_ror:12 row_mask:0xf bank_mask:0x4
  v_add_f32_dpp v9, v60, v9 row_ror:12 row_mask:0xf bank_mask:0x8
  v_add_f32_dpp v9, v50, v9 row_ror:8 row_mask:0xf bank_mask:0x1
  v_add_f32_dpp v9, v55, v9 row_ror:8 row_mask:0xf bank_mask:0x2
  v_add_f32_dpp v9, v56, v9 row_ror:8 row_mask:0xf bank_mask:0x4
  v_add_f32_dpp v9, v61, v9 row_ror:8 row_mask:0xf bank_mask:0x8
  v_add_f32_dpp v9, v51, v9 row_ror:4 row_mask:0xf bank_mask:0x1
  v_add_f32_dpp v9, v52, v9 row_ror:4 row_mask:0xf bank_mask:0x2
  v_add_f32_dpp v9, v57, v9 row_ror:4 row_mask:0xf bank_mask:0x4
  v_add_f32_dpp v9, v62, v9 row_ror:4 row_mask:0xf bank_mask:0x8
  v_cvt_pk_bf16_f32 v9, v9, v9
  v_lshlrev_b32 v9, 16, v9
  v_mul_f32 v9, 0x3db504f3, v9
  v_cvt_pk_bf16_f32 v9, v9, v9
  v_lshlrev_b32 v9, 16, v9
  v_mfma_f32_16x16x32_bf16 v[48:51], v[112:115], v[4:7], 0
  v_mfma_f32_16x16x32_bf16 v[52:55], v[116:119], v[4:7], 0
  v_mfma_f32_16x16x32_bf16 v[56:59], v[120:123], v[4:7], 0
  v_mfma_f32_16x16x32_bf16 v[60:63], v[124:127], v[4:7], 0
  v_mov_b32_dpp v10, v32 quad_perm:[0,1,2,3] row_mask:0xf bank_mask:0x1
  v_mov_b32_dpp v10, v37 quad_perm:[0,1,2,3] row_mask:0xf bank_mask:0x2
  v_mov_b32_dpp v10, v42 quad_perm:[0,1,2,3] row_mask:0xf bank_mask:0x4
  v_mov_b32_dpp v10, v47 quad_perm:[0,1,2,3] row_mask:0xf bank_mask:0x8
  v_add_f32_dpp v10, v33, v10 row_ror:12 row_mask:0xf bank_mask:0x1
  v_add_f32_dpp v10, v38, v10 row_ror:12 row_mask:0xf bank_mask:0x2
  v_add_f32_dpp v10, v43, v10 row_ror:12 row_mask:0xf bank_mask:0x4
  v_add_f32_dpp v10, v44, v10 row_ror:12 row_mask:0xf bank_mask:0x8
  v_add_f32_dpp v10, v34, v10 row_ror:8 row_mask:0xf bank_mask:0x1
  v_add_f32_dpp v10, v39, v10 row_ror:8 row_mask:0xf bank_mask:0x2
  v_add_f32_dpp v10, v40, v10 row_ror:8 row_mask:0xf bank_mask:0x4
  v_add_f32_dpp v10, v45, v10 row_ror:8 row_mask:0xf bank_mask:0x8
  v_add_f32_dpp v10, v35, v10 row_ror:4 row_mask:0xf bank_mask:0x1
  v_add_f32_dpp v10, v36, v10 row_ror:4 row_mask:0xf bank_mask:0x2
  v_add_f32_dpp v10, v41, v10 row_ror:4 row_mask:0xf bank_mask:0x4
  v_add_f32_dpp v10, v46, v10 row_ror:4 row_mask:0xf bank_mask:0x8
  v_cvt_pk_bf16_f32 v10, v10, v10
  v_lshlrev_b32 v10, 16, v10
  v_mul_f32 v10, 0x3db504f3, v10
  v_cvt_pk_bf16_f32 v10, v10, v10
  v_lshlrev_b32 v10, 16, v10
  v_mfma_f32_16x16x32_bf16 v[32:35], v[128:131], v[4:7], 0
  v_mfma_f32_16x16x32_bf16 v[36:39], v[132:135], v[4:7], 0
  v_mfma_f32_16x16x32_bf16 v[40:43], v[136:139], v[4:7], 0
  v_mfma_f32_16x16x32_bf16 v[44:47], v[140:143], v[4:7], 0
  v_mov_b32_dpp v11, v48 quad_perm:[0,1,2,3] row_mask:0xf bank_mask:0x1
  v_mov_b32_dpp v11, v53 quad_perm:[0,1,2,3] row_mask:0xf bank_mask:0x2
  v_mov_b32_dpp v11, v58 quad_perm:[0,1,2,3] row_mask:0xf bank_mask:0x4
  v_mov_b32_dpp v11, v63 quad_perm:[0,1,2,3] row_mask:0xf bank_mask:0x8
  v_add_f32_dpp v11, v49, v11 row_ror:12 row_mask:0xf bank_mask:0x1
  v_add_f32_dpp v11, v54, v11 row_ror:12 row_mask:0xf bank_mask:0x2
  v_add_f32_dpp v11, v59, v11 row_ror:12 row_mask:0xf bank_mask:0x4
  v_add_f32_dpp v11, v60, v11 row_ror:12 row_mask:0xf bank_mask:0x8
  v_add_f32_dpp v11, v50, v11 row_ror:8 row_mask:0xf bank_mask:0x1
  v_add_f32_dpp v11, v55, v11 row_ror:8 row_mask:0xf bank_mask:0x2
  v_add_f32_dpp v11, v56, v11 row_ror:8 row_mask:0xf bank_mask:0x4
  v_add_f32_dpp v11, v61, v11 row_ror:8 row_mask:0xf bank_mask:0x8
  v_add_f32_dpp v11, v51, v11 row_ror:4 row_mask:0xf bank_mask:0x1
  v_add_f32_dpp v11, v52, v11 row_ror:4 row_mask:0xf bank_mask:0x2
  v_add_f32_dpp v11, v57, v11 row_ror:4 row_mask:0xf bank_mask:0x4
  v_add_f32_dpp v11, v62, v11 row_ror:4 row_mask:0xf bank_mask:0x8
  v_cvt_pk_bf16_f32 v11, v11, v11
  v_lshlrev_b32 v11, 16, v11
  v_mul_f32 v11, 0x3db504f3, v11
  v_cvt_pk_bf16_f32 v11, v11, v11
  v_lshlrev_b32 v11, 16, v11
  v_add_f32 v11, s72, v11
  v_mfma_f32_16x16x32_bf16 v[48:51], v[144:147], v[4:7], 0
  v_mfma_f32_16x16x32_bf16 v[52:55], v[148:151], v[4:7], 0
  v_mfma_f32_16x16x32_bf16 v[56:59], v[152:155], v[4:7], 0
  v_mfma_f32_16x16x32_bf16 v[60:63], v[156:159], v[4:7], 0
  v_mov_b32_dpp v12, v32 quad_perm:[0,1,2,3] row_mask:0xf bank_mask:0x1
  v_mov_b32_dpp v12, v37 quad_perm:[0,1,2,3] row_mask:0xf bank_mask:0x2
  v_mov_b32_dpp v12, v42 quad_perm:[0,1,2,3] row_mask:0xf bank_mask:0x4
  v_mov_b32_dpp v12, v47 quad_perm:[0,1,2,3] row_mask:0xf bank_mask:0x8
  v_add_f32_dpp v12, v33, v12 row_ror:12 row_mask:0xf bank_mask:0x1
  v_add_f32_dpp v12, v38, v12 row_ror:12 row_mask:0xf bank_mask:0x2
  v_add_f32_dpp v12, v43, v12 row_ror:12 row_mask:0xf bank_mask:0x4
  v_add_f32_dpp v12, v44, v12 row_ror:12 row_mask:0xf bank_mask:0x8
  v_add_f32_dpp v12, v34, v12 row_ror:8 row_mask:0xf bank_mask:0x1
  v_add_f32_dpp v12, v39, v12 row_ror:8 row_mask:0xf bank_mask:0x2
  v_add_f32_dpp v12, v40, v12 row_ror:8 row_mask:0xf bank_mask:0x4
  v_add_f32_dpp v12, v45, v12 row_ror:8 row_mask:0xf bank_mask:0x8
  v_add_f32_dpp v12, v35, v12 row_ror:4 row_mask:0xf bank_mask:0x1
  v_add_f32_dpp v12, v36, v12 row_ror:4 row_mask:0xf bank_mask:0x2
  v_add_f32_dpp v12, v41, v12 row_ror:4 row_mask:0xf bank_mask:0x4
  v_add_f32_dpp v12, v46, v12 row_ror:4 row_mask:0xf bank_mask:0x8
  v_cvt_pk_bf16_f32 v12, v12, v12
  v_lshlrev_b32 v12, 16, v12
  v_mul_f32 v12, 0x3db504f3, v12
  v_cvt_pk_bf16_f32 v12, v12, v12
  v_lshlrev_b32 v12, 16, v12
  v_add_f32 v12, s73, v12
  v_mov_b32_dpp v13, v48 quad_perm:[0,1,2,3] row_mask:0xf bank_mask:0x1
  v_mov_b32_dpp v13, v53 quad_perm:[0,1,2,3] row_mask:0xf bank_mask:0x2
  v_mov_b32_dpp v13, v58 quad_perm:[0,1,2,3] row_mask:0xf bank_mask:0x4
  v_mov_b32_dpp v13, v63 quad_perm:[0,1,2,3] row_mask:0xf bank_mask:0x8
  v_add_f32_dpp v13, v49, v13 row_ror:12 row_mask:0xf bank_mask:0x1
  v_add_f32_dpp v13, v54, v13 row_ror:12 row_mask:0xf bank_mask:0x2
  v_add_f32_dpp v13, v59, v13 row_ror:12 row_mask:0xf bank_mask:0x4
  v_add_f32_dpp v13, v60, v13 row_ror:12 row_mask:0xf bank_mask:0x8
  v_add_f32_dpp v13, v50, v13 row_ror:8 row_mask:0xf bank_mask:0x1
  v_add_f32_dpp v13, v55, v13 row_ror:8 row_mask:0xf bank_mask:0x2
  v_add_f32_dpp v13, v56, v13 row_ror:8 row_mask:0xf bank_mask:0x4
  v_add_f32_dpp v13, v61, v13 row_ror:8 row_mask:0xf bank_mask:0x8
  v_add_f32_dpp v13, v51, v13 row_ror:4 row_mask:0xf bank_mask:0x1
  v_add_f32_dpp v13, v52, v13 row_ror:4 row_mask:0xf bank_mask:0x2
  v_add_f32_dpp v13, v57, v13 row_ror:4 row_mask:0xf bank_mask:0x4
  v_add_f32_dpp v13, v62, v13 row_ror:4 row_mask:0xf bank_mask:0x8
  v_cvt_pk_bf16_f32 v13, v13, v13
  v_lshlrev_b32 v13, 16, v13
  v_mul_f32 v13, 0x3db504f3, v13
  v_cvt_pk_bf16_f32 v13, v13, v13
  v_lshlrev_b32 v13, 16, v13
  v_add_f32 v13, s74, v13
  v_max3_f32 v14, v8, v9, v10
  v_max3_f32 v14, v14, v11, v12
  v_max_f32 v14, v14, v13
  s_nop 1
  v_max_f32_dpp v14, v14, v14 row_ror:8 row_mask:0xf bank_mask:0xf
  s_nop 1
  v_max_f32_dpp v14, v14, v14 row_ror:4 row_mask:0xf bank_mask:0xf
  v_mov_b32 v15, v14
  s_nop 1
  v_permlane16_swap_b32 v14, v15
  v_max_f32 v14, v14, v15
  v_mov_b32 v15, v14
  s_nop 1
  v_permlane32_swap_b32 v14, v15
  v_max_f32 v14, v14, v15
  s_mov_b32 s46, 0x3fb8aa3b
  v_mul_f32 v48, s46, v14
  v_fma_f32 v8, v8, s46, -v48
  v_fma_f32 v9, v9, s46, -v48
  v_fma_f32 v10, v10, s46, -v48
  v_fma_f32 v11, v11, s46, -v48
  v_fma_f32 v12, v12, s46, -v48
  v_fma_f32 v13, v13, s46, -v48
  v_exp_f32 v8, v8
  v_exp_f32 v9, v9
  v_exp_f32 v10, v10
  v_exp_f32 v11, v11
  v_exp_f32 v12, v12
  v_exp_f32 v13, v13
  v_cvt_pk_bf16_f32 v96, v8, v8
  v_and_b32 v64, 0xffff, v96
  v_and_b32 v97, 0xffff, v96
  v_and_b32 v96, 0xffff0000, v96
  v_cvt_pk_bf16_f32 v99, v9, v9
  v_and_b32 v68, 0xffff, v99
  v_and_b32 v100, 0xffff, v99
  v_and_b32 v99, 0xffff0000, v99
  v_cvt_pk_bf16_f32 v102, v10, v10
  v_and_b32 v72, 0xffff, v102
  v_and_b32 v103, 0xffff, v102
  v_and_b32 v102, 0xffff0000, v102
  v_cvt_pk_bf16_f32 v105, v11, v11
  v_and_b32 v76, 0xffff, v105
  v_and_b32 v106, 0xffff, v105
  v_and_b32 v105, 0xffff0000, v105
  v_cvt_pk_bf16_f32 v108, v12, v12
  v_and_b32 v80, 0xffff, v108
  v_and_b32 v109, 0xffff, v108
  v_and_b32 v108, 0xffff0000, v108
  v_cvt_pk_bf16_f32 v111, v13, v13
  v_and_b32 v84, 0xffff, v111
  v_and_b32 v112, 0xffff, v111
  v_and_b32 v111, 0xffff0000, v111
  v_mov_b32_dpp v64, v96 row_ror:4 row_mask:0xf bank_mask:0xa
  v_mov_b32_dpp v97, v96 row_ror:4 row_mask:0xf bank_mask:0x5
  v_mov_b32_dpp v68, v99 row_ror:4 row_mask:0xf bank_mask:0xa
  v_mov_b32_dpp v100, v99 row_ror:4 row_mask:0xf bank_mask:0x5
  v_mov_b32_dpp v72, v102 row_ror:4 row_mask:0xf bank_mask:0xa
  v_mov_b32_dpp v103, v102 row_ror:4 row_mask:0xf bank_mask:0x5
  v_mov_b32_dpp v76, v105 row_ror:4 row_mask:0xf bank_mask:0xa
  v_mov_b32_dpp v106, v105 row_ror:4 row_mask:0xf bank_mask:0x5
  v_mov_b32_dpp v80, v108 row_ror:4 row_mask:0xf bank_mask:0xa
  v_mov_b32_dpp v109, v108 row_ror:4 row_mask:0xf bank_mask:0x5
  v_mov_b32_dpp v84, v111 row_ror:4 row_mask:0xf bank_mask:0xa
  v_mov_b32_dpp v112, v111 row_ror:4 row_mask:0xf bank_mask:0x5
  v_mov_b32_dpp v65, v97 row_ror:12 row_mask:0xf bank_mask:0xf
  v_mov_b32_dpp v66, v64 row_ror:8 row_mask:0xf bank_mask:0xf
  v_mov_b32_dpp v67, v97 row_ror:4 row_mask:0xf bank_mask:0xf
  v_mov_b32_dpp v69, v100 row_ror:12 row_mask:0xf bank_mask:0xf
  v_mov_b32_dpp v70, v68 row_ror:8 row_mask:0xf bank_mask:0xf
  v_mov_b32_dpp v71, v100 row_ror:4 row_mask:0xf bank_mask:0xf
  v_mov_b32_dpp v73, v103 row_ror:12 row_mask:0xf bank_mask:0xf
  v_mov_b32_dpp v74, v72 row_ror:8 row_mask:0xf bank_mask:0xf
  v_mov_b32_dpp v75, v103 row_ror:4 row_mask:0xf bank_mask:0xf
  v_mov_b32_dpp v77, v106 row_ror:12 row_mask:0xf bank_mask:0xf
  v_mov_b32_dpp v78, v76 row_ror:8 row_mask:0xf bank_mask:0xf
  v_mov_b32_dpp v79, v106 row_ror:4 row_mask:0xf bank_mask:0xf
  v_mov_b32_dpp v81, v109 row_ror:12 row_mask:0xf bank_mask:0xf
  v_mov_b32_dpp v82, v80 row_ror:8 row_mask:0xf bank_mask:0xf
  v_mov_b32_dpp v83, v109 row_ror:4 row_mask:0xf bank_mask:0xf
  v_mov_b32_dpp v85, v112 row_ror:12 row_mask:0xf bank_mask:0xf
  v_mov_b32_dpp v86, v84 row_ror:8 row_mask:0xf bank_mask:0xf
  v_mov_b32_dpp v87, v112 row_ror:4 row_mask:0xf bank_mask:0xf
  v_add_f32 v8, v8, v9
  v_add_f32 v10, v10, v11
  v_add_f32 v12, v12, v13
  v_add_f32 v8, v8, v10
  v_add_f32 v15, v8, v12
  s_nop 1
  v_add_f32_dpp v15, v15, v15 row_ror:8 row_mask:0xf bank_mask:0xf
  s_nop 1
  v_add_f32_dpp v15, v15, v15 row_ror:4 row_mask:0xf bank_mask:0xf
  v_mov_b32 v9, v15
  s_nop 1
  v_permlane16_swap_b32 v15, v9
  v_add_f32 v15, v15, v9
  v_mov_b32 v9, v15
  s_nop 1
  v_permlane32_swap_b32 v15, v9
  v_add_f32 v15, v15, v9
  v_and_b32 v8, 3, v0
  v_lshlrev_b32 v8, 6, v8
  s_lshl_b32 s46, s3, 3
  v_add_u32 v8, s46, v8
  s_and_b32 exec_lo, s6, 0xf
  s_and_b32 exec_hi, s7, 0x0
  ds_write_b64 v8, v[14:15] offset:56
  s_mov_b64 exec, s[6:7]
  v_and_b32 v63, 3, v0
  v_lshlrev_b32 v63, 9, v63
  v_lshrrev_b32 v15, 4, v0
  v_lshl_add_u32 v63, v15, 7, v63
  v_bfe_u32 v15, v0, 2, 1
  v_lshl_add_u32 v63, v15, 4, v63
  s_lshl_b32 s46, s3, 11
  v_add_u32 v63, s46, v63
  s_nop 1
  s_setpc_b64 s[98:99]
L_att_vphase:
  s_cbranch_execz Lg_17
  s_waitcnt vmcnt(20)
Lg_17:
  v_swap_b32 v161, v164
  v_swap_b32 v162, v168
  v_swap_b32 v163, v172
  v_swap_b32 v166, v169
  v_swap_b32 v167, v173
  v_swap_b32 v171, v174
  v_mfma_f32_16x16x32_bf16 v[16:19], v[160:163], v[64:67], 0
  v_mfma_f32_16x16x32_bf16 v[20:23], v[164:167], v[64:67], 0
  v_mfma_f32_16x16x32_bf16 v[24:27], v[168:171], v[64:67], 0
  v_mfma_f32_16x16x32_bf16 v[28:31], v[172:175], v[64:67], 0
  s_cbranch_execz Lg_18
  s_waitcnt vmcnt(16)
Lg_18:
  v_swap_b32 v177, v180
  v_swap_b32 v178, v184
  v_swap_b32 v179, v188
  v_swap_b32 v182, v185
  v_swap_b32 v183, v189
  v_swap_b32 v187, v190
  v_mfma_f32_16x16x32_bf16 v[16:19], v[176:179], v[68:71], v[16:19]
  v_mfma_f32_16x16x32_bf16 v[20:23], v[180:183], v[68:71], v[20:23]
  v_mfma_f32_16x16x32_bf16 v[24:27], v[184:187], v[68:71], v[24:27]
  v_mfma_f32_16x16x32_bf16 v[28:31], v[188:191], v[68:71], v[28:31]
  s_cbranch_execz Lg_19
  s_waitcnt vmcnt(12)
Lg_19:
  v_swap_b32 v193, v196
  v_swap_b32 v194, v200
  v_swap_b32 v195, v204
  v_swap_b32 v198, v201
  v_swap_b32 v199, v205
  v_swap_b32 v203, v206
  v_mfma_f32_16x16x32_bf16 v[16:19], v[192:195], v[72:75], v[16:19]
  v_mfma_f32_16x16x32_bf16 v[20:23], v[196:199], v[72:75], v[20:23]
  v_mfma_f32_16x16x32_bf16 v[24:27], v[200:203], v[72:75], v[24:27]
  v_mfma_f32_16x16x32_bf16 v[28:31], v[204:207], v[72:75], v[28:31]
  s_cbranch_execz Lg_20
  s_waitcnt vmcnt(8)
Lg_20:
  v_swap_b32 v209, v212
  v_swap_b32 v210, v216
  v_swap_b32 v211, v220
  v_swap_b32 v214, v217
  v_swap_b32 v215, v221
  v_swap_b32 v219, v222
  v_mfma_f32_16x16x32_bf16 v[16:19], v[208:211], v[76:79], v[16:19]
  v_mfma_f32_16x16x32_bf16 v[20:23], v[212:215], v[76:79], v[20:23]
  v_mfma_f32_16x16x32_bf16 v[24:27], v[216:219], v[76:79], v[24:27]
  v_mfma_f32_16x16x32_bf16 v[28:31], v[220:223], v[76:79], v[28:31]
  s_cbranch_execz Lg_21
  s_waitcnt vmcnt(4)
Lg_21:
  v_swap_b32 v225, v228
  v_swap_b32 v226, v232
  v_swap_b32 v227, v236
  v_swap_b32 v230, v233
  v_swap_b32 v231, v237
  v_swap_b32 v235, v238
  v_mfma_f32_16x16x32_bf16 v[16:19], v[224:227], v[80:83], v[16:19]
  v_mfma_f32_16x16x32_bf16 v[20:23], v[228:231], v[80:83], v[20:23]
  v_mfma_f32_16x16x32_bf16 v[24:27], v[232:235], v[80:83], v[24:27]
  v_mfma_f32_16x16x32_bf16 v[28:31], v[236:239], v[80:83], v[28:31]
  s_cbranch_execz Lg_22
  s_waitcnt vmcnt(0)
Lg_22:
  v_swap_b32 v241, v244
  v_swap_b32 v242, v248
  v_swap_b32 v243, v252
  v_swap_b32 v246, v249
  v_swap_b32 v247, v253
  v_swap_b32 v251, v254
  v_mfma_f32_16x16x32_bf16 v[16:19], v[240:243], v[84:87], v[16:19]
  v_mfma_f32_16x16x32_bf16 v[20:23], v[244:247], v[84:87], v[20:23]
  v_mfma_f32_16x16x32_bf16 v[24:27], v[248:251], v[84:87], v[24:27]
  v_mfma_f32_16x16x32_bf16 v[28:31], v[252:255], v[84:87], v[28:31]
  s_and_b32 exec_lo, s6, 0xff00ff
  s_and_b32 exec_hi, s7, 0xff00ff
  s_nop 2
  ds_write_b128 v63, v[16:19] offset:0
  ds_write_b128 v63, v[20:23] offset:32
  ds_write_b128 v63, v[24:27] offset:64
  ds_write_b128 v63, v[28:31] offset:96
  s_mov_b64 exec, s[6:7]
  s_cbranch_execz Lg_23
  s_waitcnt lgkmcnt(0)
  s_barrier
  s_branch L_done
Lg_23:
  s_branch L_att_dry_ret
.p2align 6
L_chain_compute:
  s_cbranch_execz Lg_24
  s_waitcnt vmcnt(2)
Lg_24:
  s_mov_b32 s46, 0xbfb8aa3b
  v_lshlrev_b32 v184, 16, v8
  v_and_b32 v185, 0xffff0000, v8
  v_mul_f32 v186, s46, v184
  v_mul_f32 v187, s46, v185
  v_exp_f32 v186, v186
  v_exp_f32 v187, v187
  v_add_f32 v186, 1.0, v186
  v_add_f32 v187, 1.0, v187
  v_rcp_f32 v188, v186
  v_rcp_f32 v189, v187
  v_mul_f32 v190, v184, v188
  v_mul_f32 v191, v185, v189
  v_fma_f32 v184, -v190, v186, v184
  v_fma_f32 v185, -v191, v187, v185
  v_fma_f32 v190, v184, v188, v190
  v_fma_f32 v191, v185, v189, v191
  v_cvt_pk_bf16_f32 v184, v190, v191
  ds_write_b32 v13, v184 offset:1536
  s_waitcnt lgkmcnt(0)
  ds_read_b128 v[168:171], v14 offset:1536
  ds_read_b128 v[172:175], v14 offset:1552
  v_perm_b32 v144, v20, v16, s48
  v_perm_b32 v20, v20, v16, s49
  v_perm_b32 v16, v21, v17, s48
  v_perm_b32 v21, v21, v17, s49
  v_perm_b32 v17, v22, v18, s48
  v_perm_b32 v22, v22, v18, s49
  v_perm_b32 v18, v23, v19, s48
  v_perm_b32 v23, v23, v19, s49
  v_perm_b32 v19, v28, v24, s48
  v_perm_b32 v28, v28, v24, s49
  v_perm_b32 v24, v29, v25, s48
  v_perm_b32 v29, v29, v25, s49
  v_perm_b32 v25, v30, v26, s48
  v_perm_b32 v30, v30, v26, s49
  v_perm_b32 v26, v31, v27, s48
  v_perm_b32 v31, v31, v27, s49
  v_perm_b32 v27, v36, v32, s48
  v_perm_b32 v36, v36, v32, s49
  v_perm_b32 v32, v37, v33, s48
  v_perm_b32 v37, v37, v33, s49
  v_perm_b32 v33, v38, v34, s48
  v_perm_b32 v38, v38, v34, s49
  v_perm_b32 v34, v39, v35, s48
  v_perm_b32 v39, v39, v35, s49
  v_perm_b32 v35, v44, v40, s48
  v_perm_b32 v44, v44, v40, s49
  v_perm_b32 v40, v45, v41, s48
  v_perm_b32 v45, v45, v41, s49
  v_perm_b32 v41, v46, v42, s48
  v_perm_b32 v46, v46, v42, s49
  v_perm_b32 v42, v47, v43, s48
  v_perm_b32 v47, v47, v43, s49
  v_perm_b32 v43, v52, v48, s48
  v_perm_b32 v52, v52, v48, s49
  v_perm_b32 v48, v53, v49, s48
  v_perm_b32 v53, v53, v49, s49
  v_perm_b32 v49, v54, v50, s48
  v_perm_b32 v54, v54, v50, s49
  v_perm_b32 v50, v55, v51, s48
  v_perm_b32 v55, v55, v51, s49
  v_perm_b32 v51, v60, v56, s48
  v_perm_b32 v60, v60, v56, s49
  v_perm_b32 v56, v61, v57, s48
  v_perm_b32 v61, v61, v57, s49
  v_perm_b32 v57, v62, v58, s48
  v_perm_b32 v62, v62, v58, s49
  v_perm_b32 v58, v63, v59, s48
  v_perm_b32 v63, v63, v59, s49
  v_perm_b32 v59, v68, v64, s48
  v_perm_b32 v68, v68, v64, s49
  v_perm_b32 v64, v69, v65, s48
  v_perm_b32 v69, v69, v65, s49
  v_perm_b32 v65, v70, v66, s48
  v_perm_b32 v70, v70, v66, s49
  v_perm_b32 v66, v71, v67, s48
  v_perm_b32 v71, v71, v67, s49
  v_perm_b32 v67, v76, v72, s48
  v_perm_b32 v76, v76, v72, s49
  v_perm_b32 v72, v77, v73, s48
  v_perm_b32 v77, v77, v73, s49
  v_perm_b32 v73, v78, v74, s48
  v_perm_b32 v78, v78, v74, s49
  v_perm_b32 v74, v79, v75, s48
  v_perm_b32 v79, v79, v75, s49
  v_add_u32 v185, 0x9e3779b9, v10
  s_waitcnt lgkmcnt(0)
  v_readfirstlane_b32 s59, v185
  s_mov_b32 s61, 0
  s_cmp_ge_u32 s60, 192
  s_cbranch_scc1 L_ch_noA2
  s_nop 1
L_ch_gemvA:
  v_dot2_f32_bf16 v176, v144, v168, 0
  v_dot2_f32_bf16 v177, v20, v168, 0
  v_dot2_f32_bf16 v178, v16, v168, 0
  v_dot2_f32_bf16 v179, v21, v168, 0
  v_dot2_f32_bf16 v180, v17, v168, 0
  v_dot2_f32_bf16 v181, v22, v168, 0
  v_dot2_f32_bf16 v182, v18, v168, 0
  v_dot2_f32_bf16 v183, v23, v168, 0
  v_dot2_f32_bf16 v176, v19, v169, v176
  v_dot2_f32_bf16 v177, v28, v169, v177
  v_dot2_f32_bf16 v178, v24, v169, v178
  v_dot2_f32_bf16 v179, v29, v169, v179
  v_dot2_f32_bf16 v180, v25, v169, v180
  v_dot2_f32_bf16 v181, v30, v169, v181
  v_dot2_f32_bf16 v182, v26, v169, v182
  v_dot2_f32_bf16 v183, v31, v169, v183
  v_dot2_f32_bf16 v176, v27, v170, v176
  v_dot2_f32_bf16 v177, v36, v170, v177
  v_dot2_f32_bf16 v178, v32, v170, v178
  v_dot2_f32_bf16 v179, v37, v170, v179
  v_dot2_f32_bf16 v180, v33, v170, v180
  v_dot2_f32_bf16 v181, v38, v170, v181
  v_dot2_f32_bf16 v182, v34, v170, v182
  v_dot2_f32_bf16 v183, v39, v170, v183
  v_dot2_f32_bf16 v176, v35, v171, v176
  v_dot2_f32_bf16 v177, v44, v171, v177
  v_dot2_f32_bf16 v178, v40, v171, v178
  v_dot2_f32_bf16 v179, v45, v171, v179
  v_dot2_f32_bf16 v180, v41, v171, v180
  v_dot2_f32_bf16 v181, v46, v171, v181
  v_dot2_f32_bf16 v182, v42, v171, v182
  v_dot2_f32_bf16 v183, v47, v171, v183
  v_dot2_f32_bf16 v176, v43, v172, v176
  v_dot2_f32_bf16 v177, v52, v172, v177
  v_dot2_f32_bf16 v178, v48, v172, v178
  v_dot2_f32_bf16 v179, v53, v172, v179
  v_dot2_f32_bf16 v180, v49, v172, v180
  v_dot2_f32_bf16 v181, v54, v172, v181
  v_dot2_f32_bf16 v182, v50, v172, v182
  v_dot2_f32_bf16 v183, v55, v172, v183
  v_dot2_f32_bf16 v176, v51, v173, v176
  v_dot2_f32_bf16 v177, v60, v173, v177
  v_dot2_f32_bf16 v178, v56, v173, v178
  v_dot2_f32_bf16 v179, v61, v173, v179
  v_dot2_f32_bf16 v180, v57, v173, v180
  v_dot2_f32_bf16 v181, v62, v173, v181
  v_dot2_f32_bf16 v182, v58, v173, v182
  v_dot2_f32_bf16 v183, v63, v173, v183
  v_dot2_f32_bf16 v176, v59, v174, v176
  v_dot2_f32_bf16 v177, v68, v174, v177
  v_dot2_f32_bf16 v178, v64, v174, v178
  v_dot2_f32_bf16 v179, v69, v174, v179
  v_dot2_f32_bf16 v180, v65, v174, v180
  v_dot2_f32_bf16 v181, v70, v174, v181
  v_dot2_f32_bf16 v182, v66, v174, v182
  v_dot2_f32_bf16 v183, v71, v174, v183
  v_dot2_f32_bf16 v176, v67, v175, v176
  v_dot2_f32_bf16 v177, v76, v175, v177
  v_dot2_f32_bf16 v178, v72, v175, v178
  v_dot2_f32_bf16 v179, v77, v175, v179
  v_dot2_f32_bf16 v180, v73, v175, v180
  v_dot2_f32_bf16 v181, v78, v175, v181
  v_dot2_f32_bf16 v182, v74, v175, v182
  v_dot2_f32_bf16 v183, v79, v175, v183
  v_permlane32_swap_b32 v176, v180
  v_permlane32_swap_b32 v177, v181
  v_permlane32_swap_b32 v178, v182
  v_permlane32_swap_b32 v179, v183
  v_add_f32 v176, v176, v180
  v_add_f32 v177, v177, v181
  v_add_f32 v178, v178, v182
  v_add_f32 v179, v179, v183
  s_nop 0
  v_permlane16_swap_b32 v176, v178
  v_permlane16_swap_b32 v177, v179
  v_add_f32 v176, v176, v178
  v_add_f32 v177, v177, v179
  s_nop 0
  v_add_f32_dpp v184, v176, v176 row_ror:8 row_mask:0xf bank_mask:0x3
  v_add_f32_dpp v184, v177, v177 row_ror:8 row_mask:0xf bank_mask:0xc
  v_mov_b32 v185, s59
  s_cbranch_execz Lg_25
  global_store_dwordx2 v12, v[184:185], s[34:35] sc1
Lg_25:
  s_cmp_lg_u32 s61, 0
  s_cbranch_scc1 L_ch_gemvA_ret
L_ch_noA2:
  s_lshl_b32 s46, s57, 10
  s_add_u32 s46, s46, 0x1000
  v_add_u32 v3, s46, v2
  s_cbranch_execz Lg_26
  global_load_dwordx4 v[4:7], v2, s[8:9]
  global_load_dword v9, v147, s[8:9]
  s_mov_b32 s44, s14
  s_mov_b32 s45, s15
  global_load_dwordx4 v[80:83], v146, s[44:45] nt
  s_add_u32 s44, s44, 8192
  s_addc_u32 s45, s45, 0
  global_load_dwordx4 v[84:87], v146, s[44:45] nt
  s_add_u32 s44, s44, 8192
  s_addc_u32 s45, s45, 0
  global_load_dwordx4 v[88:91], v146, s[44:45] nt
  s_add_u32 s44, s44, 8192
  s_addc_u32 s45, s45, 0
  global_load_dwordx4 v[92:95], v146, s[44:45] nt
  s_add_u32 s44, s44, 8192
  s_addc_u32 s45, s45, 0
  global_load_dwordx4 v[96:99], v146, s[44:45] nt
  s_add_u32 s44, s44, 8192
  s_addc_u32 s45, s45, 0
  global_load_dwordx4 v[100:103], v146, s[44:45] nt
  s_add_u32 s44, s44, 8192
  s_addc_u32 s45, s45, 0
  global_load_dwordx4 v[104:107], v146, s[44:45] nt
  s_add_u32 s44, s44, 8192
  s_addc_u32 s45, s45, 0
  global_load_dwordx4 v[108:111], v146, s[44:45] nt
  s_add_u32 s44, s44, 8192
  s_addc_u32 s45, s45, 0
  global_load_dwordx4 v[112:115], v146, s[44:45] nt
  s_add_u32 s44, s44, 8192
  s_addc_u32 s45, s45, 0
  global_load_dwordx4 v[116:119], v146, s[44:45] nt
  s_add_u32 s44, s44, 8192
  s_addc_u32 s45, s45, 0
  global_load_dwordx4 v[120:123], v146, s[44:45] nt
  s_add_u32 s44, s44, 8192
  s_addc_u32 s45, s45, 0
  global_load_dwordx4 v[124:127], v146, s[44:45] nt
  s_add_u32 s44, s44, 8192
  s_addc_u32 s45, s45, 0
  global_load_dwordx4 v[128:131], v146, s[44:45] nt
  s_add_u32 s44, s44, 8192
  s_addc_u32 s45, s45, 0
  global_load_dwordx4 v[132:135], v146, s[44:45] nt
  s_add_u32 s44, s44, 8192
  s_addc_u32 s45, s45, 0
  global_load_dwordx4 v[136:139], v146, s[44:45] nt
  s_add_u32 s44, s44, 8192
  s_addc_u32 s45, s45, 0
  global_load_dwordx4 v[140:143], v146, s[44:45] nt
  s_add_u32 s44, s34, 0
  s_addc_u32 s45, s35, 0
  global_load_dwordx4 v[192:195], v3, s[44:45] sc1
  s_add_u32 s44, s34, 4096
  s_addc_u32 s45, s35, 0
  global_load_dwordx4 v[196:199], v3, s[44:45] sc1
  s_add_u32 s44, s34, 8192
  s_addc_u32 s45, s35, 0
  global_load_dwordx4 v[200:203], v3, s[44:45] sc1
  s_add_u32 s44, s34, 12288
  s_addc_u32 s45, s35, 0
  global_load_dwordx4 v[204:207], v3, s[44:45] sc1
  s_add_u32 s44, s34, 16384
  s_addc_u32 s45, s35, 0
  global_load_dwordx4 v[208:211], v3, s[44:45] sc1
  s_add_u32 s44, s34, 20480
  s_addc_u32 s45, s35, 0
  global_load_dwordx4 v[212:215], v3, s[44:45] sc1
  s_add_u32 s44, s34, 24576
  s_addc_u32 s45, s35, 0
  global_load_dwordx4 v[216:219], v3, s[44:45] sc1
  s_add_u32 s44, s34, 28672
  s_addc_u32 s45, s35, 0
  global_load_dwordx4 v[220:223], v3, s[44:45] sc1
  s_waitcnt vmcnt(24)
Lg_26:
  s_mov_b32 s64, 0x3f803f80
  v_dot2_f32_bf16 v184, v4, s64, 0
  v_dot2_f32_bf16 v185, v4, v4, 0
  v_dot2_f32_bf16 v184, v5, s64, v184
  v_dot2_f32_bf16 v185, v5, v5, v185
  v_dot2_f32_bf16 v184, v6, s64, v184
  v_dot2_f32_bf16 v185, v6, v6, v185
  v_dot2_f32_bf16 v184, v7, s64, v184
  v_dot2_f32_bf16 v185, v7, v7, v185
  s_nop 2
  v_permlane32_swap_b32 v184, v185
  v_add_f32 v184, v184, v185
  v_mov_b32 v186, v184
  s_nop 1
  v_permlane16_swap_b32 v184, v186
  v_add_f32 v184, v184, v186
  s_nop 1
  v_add_f32_dpp v184, v184, v184 row_ror:8 row_mask:0xf bank_mask:0xf
  s_nop 1
  v_add_f32_dpp v184, v184, v184 row_ror:4 row_mask:0xf bank_mask:0xf
  s_nop 1
  v_add_f32_dpp v184, v184, v184 quad_perm:[2,3,0,1] row_mask:0xf bank_mask:0xf
  s_nop 1
  v_add_f32_dpp v184, v184, v184 quad_perm:[1,0,3,2] row_mask:0xf bank_mask:0xf
  s_nop 0
  v_readlane_b32 s64, v184, 0
  v_readlane_b32 s65, v184, 32
  v_mov_b32 v186, 0x3b000000
  v_mul_f32 v184, s64, v186
  v_mul_f32 v185, s65, v186
  v_fma_f32 v185, -v184, v184, v185
  v_max_f32 v185, 0, v185
  v_cvt_pk_bf16_f32 v184, v184, v185
  v_and_b32 v185, 0xffff0000, v184
  v_lshlrev_b32 v184, 16, v184
  v_add_f32 v185, 0x3727c5ac, v185
  v_cvt_pk_bf16_f32 v185, v185, v185
  v_lshlrev_b32 v185, 16, v185
  v_sqrt_f32 v185, v185
  s_nop 0
  v_cvt_pk_bf16_f32 v185, v185, v185
  v_lshlrev_b32 v185, 16, v185
  v_rcp_f32 v186, v185
  s_nop 0
  v_fma_f32 v187, -v185, v186, 1.0
  v_fma_f32 v186, v187, v186, v186
  v_readfirstlane_b32 s64, v184
  v_readfirstlane_b32 s65, v186
  v_readfirstlane_b32 s66, v185
  v_lshlrev_b32 v4, 16, v9
  v_and_b32 v5, 0xffff0000, v9
  v_subrev_f32 v4, s64, v4
  v_subrev_f32 v5, s64, v5
  v_cvt_pk_bf16_f32 v5, v4, v5
  v_lshlrev_b32 v4, 16, v5
  v_and_b32 v5, 0xffff0000, v5
  v_mul_f32 v6, s65, v4
  v_mul_f32 v7, s65, v5
  v_fma_f32 v4, -v6, s66, v4
  v_fma_f32 v5, -v7, s66, v5
  v_fma_f32 v4, v4, s65, v6
  v_fma_f32 v5, v5, s65, v7
  v_cvt_pk_bf16_f32 v5, v4, v5
  v_lshlrev_b32 v4, 16, v5
  v_and_b32 v5, 0xffff0000, v5
  s_cbranch_execz Lg_27
  s_waitcnt vmcnt(8)
Lg_27:
  v_perm_b32 v75, v84, v80, s48
  v_perm_b32 v84, v84, v80, s49
  v_perm_b32 v80, v85, v81, s48
  v_perm_b32 v85, v85, v81, s49
  v_perm_b32 v81, v86, v82, s48
  v_perm_b32 v86, v86, v82, s49
  v_perm_b32 v82, v87, v83, s48
  v_perm_b32 v87, v87, v83, s49
  v_perm_b32 v83, v92, v88, s48
  v_perm_b32 v92, v92, v88, s49
  v_perm_b32 v88, v93, v89, s48
  v_perm_b32 v93, v93, v89, s49
  v_perm_b32 v89, v94, v90, s48
  v_perm_b32 v94, v94, v90, s49
  v_perm_b32 v90, v95, v91, s48
  v_perm_b32 v95, v95, v91, s49
  v_perm_b32 v91, v100, v96, s48
  v_perm_b32 v100, v100, v96, s49
  v_perm_b32 v96, v101, v97, s48
  v_perm_b32 v101, v101, v97, s49
  v_perm_b32 v97, v102, v98, s48
  v_perm_b32 v102, v102, v98, s49
  v_perm_b32 v98, v103, v99, s48
  v_perm_b32 v103, v103, v99, s49
  v_perm_b32 v99, v108, v104, s48
  v_perm_b32 v108, v108, v104, s49
  v_perm_b32 v104, v109, v105, s48
  v_perm_b32 v109, v109, v105, s49
  v_perm_b32 v105, v110, v106, s48
  v_perm_b32 v110, v110, v106, s49
  v_perm_b32 v106, v111, v107, s48
  v_perm_b32 v111, v111, v107, s49
  v_perm_b32 v107, v116, v112, s48
  v_perm_b32 v116, v116, v112, s49
  v_perm_b32 v112, v117, v113, s48
  v_perm_b32 v117, v117, v113, s49
  v_perm_b32 v113, v118, v114, s48
  v_perm_b32 v118, v118, v114, s49
  v_perm_b32 v114, v119, v115, s48
  v_perm_b32 v119, v119, v115, s49
  v_perm_b32 v115, v124, v120, s48
  v_perm_b32 v124, v124, v120, s49
  v_perm_b32 v120, v125, v121, s48
  v_perm_b32 v125, v125, v121, s49
  v_perm_b32 v121, v126, v122, s48
  v_perm_b32 v126, v126, v122, s49
  v_perm_b32 v122, v127, v123, s48
  v_perm_b32 v127, v127, v123, s49
  v_perm_b32 v123, v132, v128, s48
  v_perm_b32 v132, v132, v128, s49
  v_perm_b32 v128, v133, v129, s48
  v_perm_b32 v133, v133, v129, s49
  v_perm_b32 v129, v134, v130, s48
  v_perm_b32 v134, v134, v130, s49
  v_perm_b32 v130, v135, v131, s48
  v_perm_b32 v135, v135, v131, s49
  v_perm_b32 v131, v140, v136, s48
  v_perm_b32 v140, v140, v136, s49
  v_perm_b32 v136, v141, v137, s48
  v_perm_b32 v141, v141, v137, s49
  v_perm_b32 v137, v142, v138, s48
  v_perm_b32 v142, v142, v138, s49
  v_perm_b32 v138, v143, v139, s48
  v_perm_b32 v143, v143, v139, s49
  s_cbranch_execz Lg_28
  s_mov_b32 s63, 262144
  s_branch L_ch_mpchk
  s_mov_b32 s63, 262144
Lp_29:
  s_sub_u32 s63, s63, 1
  s_cbranch_scc1 Lq_30
  s_add_u32 s44, s34, 0
  s_addc_u32 s45, s35, 0
  global_load_dwordx4 v[192:195], v3, s[44:45] sc1
  s_add_u32 s44, s34, 4096
  s_addc_u32 s45, s35, 0
  global_load_dwordx4 v[196:199], v3, s[44:45] sc1
  s_add_u32 s44, s34, 8192
  s_addc_u32 s45, s35, 0
  global_load_dwordx4 v[200:203], v3, s[44:45] sc1
  s_add_u32 s44, s34, 12288
  s_addc_u32 s45, s35, 0
  global_load_dwordx4 v[204:207], v3, s[44:45] sc1
  s_add_u32 s44, s34, 16384
  s_addc_u32 s45, s35, 0
  global_load_dwordx4 v[208:211], v3, s[44:45] sc1
  s_add_u32 s44, s34, 20480
  s_addc_u32 s45, s35, 0
  global_load_dwordx4 v[212:215], v3, s[44:45] sc1
  s_add_u32 s44, s34, 24576
  s_addc_u32 s45, s35, 0
  global_load_dwordx4 v[216:219], v3, s[44:45] sc1
  s_add_u32 s44, s34, 28672
  s_addc_u32 s45, s35, 0
  global_load_dwordx4 v[220:223], v3, s[44:45] sc1
L_ch_mpchk:
  s_waitcnt vmcnt(0)
  v_min3_u32 v184, v193, v195, v197
  v_min3_u32 v184, v184, v199, v201
  v_min3_u32 v184, v184, v203, v205
  v_min3_u32 v184, v184, v207, v209
  v_min3_u32 v184, v184, v211, v213
  v_min3_u32 v184, v184, v215, v217
  v_min3_u32 v184, v184, v219, v221
  v_min_u32 v184, v184, v223
  v_max3_u32 v185, v193, v195, v197
  v_max3_u32 v185, v185, v199, v201
  v_max3_u32 v185, v185, v203, v205
  v_max3_u32 v185, v185, v207, v209
  v_max3_u32 v185, v185, v211, v213
  v_max3_u32 v185, v185, v215, v217
  v_max3_u32 v185, v185, v219, v221
  v_max_u32 v185, v185, v223
  v_cmp_ne_u32 vcc, s59, v184
  v_cmp_ne_u32 s[44:45], s59, v185
  s_nop 0
  s_or_b64 vcc, vcc, s[44:45]
  s_cbranch_vccnz Lp_29
Lq_30:
Lg_28:
  v_add_f32 v192, v192, v200
  v_add_f32 v208, v208, v216
  v_add_f32 v152, v192, v208
  v_add_f32 v194, v194, v202
  v_add_f32 v210, v210, v218
  v_add_f32 v153, v194, v210
  v_add_f32 v196, v196, v204
  v_add_f32 v212, v212, v220
  v_add_f32 v154, v196, v212
  v_add_f32 v198, v198, v206
  v_add_f32 v214, v214, v222
  v_add_f32 v155, v198, v214
  v_cvt_pk_bf16_f32 v153, v152, v153
  v_lshlrev_b32 v152, 16, v153
  v_and_b32 v153, 0xffff0000, v153
  v_cvt_pk_bf16_f32 v155, v154, v155
  v_lshlrev_b32 v154, 16, v155
  v_and_b32 v155, 0xffff0000, v155
  v_add_f32 v154, 1.0, v154
  v_add_f32 v155, 1.0, v155
  v_cvt_pk_bf16_f32 v155, v154, v155
  v_lshlrev_b32 v154, 16, v155
  v_and_b32 v155, 0xffff0000, v155
  v_mul_f32 v4, v4, v154
  v_mul_f32 v5, v5, v155
  v_cvt_pk_bf16_f32 v5, v4, v5
  v_lshlrev_b32 v4, 16, v5
  v_and_b32 v5, 0xffff0000, v5
  v_add_f32 v4, v4, v152
  v_add_f32 v5, v5, v153
  v_cvt_pk_bf16_f32 v4, v4, v5
  ds_write_b32 v13, v4 offset:1536
  s_waitcnt lgkmcnt(0)
  ds_read_b128 v[168:171], v14 offset:1536
  ds_read_b128 v[172:175], v14 offset:1552
  s_lshl_b32 s46, s57, 15
  s_lshl_b32 s54, s58, 9
  s_add_u32 s46, s46, s54
  s_add_u32 s46, s46, 0x19000
  v_add_u32 v3, s46, v11
  s_waitcnt lgkmcnt(0)
  v_dot2_f32_bf16 v176, v75, v168, 0
  v_dot2_f32_bf16 v177, v84, v168, 0
  v_dot2_f32_bf16 v178, v80, v168, 0
  v_dot2_f32_bf16 v179, v85, v168, 0
  v_dot2_f32_bf16 v180, v81, v168, 0
  v_dot2_f32_bf16 v181, v86, v168, 0
  v_dot2_f32_bf16 v182, v82, v168, 0
  v_dot2_f32_bf16 v183, v87, v168, 0
  v_dot2_f32_bf16 v176, v83, v169, v176
  v_dot2_f32_bf16 v177, v92, v169, v177
  v_dot2_f32_bf16 v178, v88, v169, v178
  v_dot2_f32_bf16 v179, v93, v169, v179
  v_dot2_f32_bf16 v180, v89, v169, v180
  v_dot2_f32_bf16 v181, v94, v169, v181
  v_dot2_f32_bf16 v182, v90, v169, v182
  v_dot2_f32_bf16 v183, v95, v169, v183
  v_dot2_f32_bf16 v176, v91, v170, v176
  v_dot2_f32_bf16 v177, v100, v170, v177
  v_dot2_f32_bf16 v178, v96, v170, v178
  v_dot2_f32_bf16 v179, v101, v170, v179
  v_dot2_f32_bf16 v180, v97, v170, v180
  v_dot2_f32_bf16 v181, v102, v170, v181
  v_dot2_f32_bf16 v182, v98, v170, v182
  v_dot2_f32_bf16 v183, v103, v170, v183
  v_dot2_f32_bf16 v176, v99, v171, v176
  v_dot2_f32_bf16 v177, v108, v171, v177
  v_dot2_f32_bf16 v178, v104, v171, v178
  v_dot2_f32_bf16 v179, v109, v171, v179
  v_dot2_f32_bf16 v180, v105, v171, v180
  v_dot2_f32_bf16 v181, v110, v171, v181
  v_dot2_f32_bf16 v182, v106, v171, v182
  v_dot2_f32_bf16 v183, v111, v171, v183
  v_dot2_f32_bf16 v176, v107, v172, v176
  v_dot2_f32_bf16 v177, v116, v172, v177
  v_dot2_f32_bf16 v178, v112, v172, v178
  v_dot2_f32_bf16 v179, v117, v172, v179
  v_dot2_f32_bf16 v180, v113, v172, v180
  v_dot2_f32_bf16 v181, v118, v172, v181
  v_dot2_f32_bf16 v182, v114, v172, v182
  v_dot2_f32_bf16 v183, v119, v172, v183
  v_dot2_f32_bf16 v176, v115, v173, v176
  v_dot2_f32_bf16 v177, v124, v173, v177
  v_dot2_f32_bf16 v178, v120, v173, v178
  v_dot2_f32_bf16 v179, v125, v173, v179
  v_dot2_f32_bf16 v180, v121, v173, v180
  v_dot2_f32_bf16 v181, v126, v173, v181
  v_dot2_f32_bf16 v182, v122, v173, v182
  v_dot2_f32_bf16 v183, v127, v173, v183
  v_dot2_f32_bf16 v176, v123, v174, v176
  v_dot2_f32_bf16 v177, v132, v174, v177
  v_dot2_f32_bf16 v178, v128, v174, v178
  v_dot2_f32_bf16 v179, v133, v174, v179
  v_dot2_f32_bf16 v180, v129, v174, v180
  v_dot2_f32_bf16 v181, v134, v174, v181
  v_dot2_f32_bf16 v182, v130, v174, v182
  v_dot2_f32_bf16 v183, v135, v174, v183
  v_dot2_f32_bf16 v176, v131, v175, v176
  v_dot2_f32_bf16 v177, v140, v175, v177
  v_dot2_f32_bf16 v178, v136, v175, v178
  v_dot2_f32_bf16 v179, v141, v175, v179
  v_dot2_f32_bf16 v180, v137, v175, v180
  v_dot2_f32_bf16 v181, v142, v175, v181
  v_dot2_f32_bf16 v182, v138, v175, v182
  v_dot2_f32_bf16 v183, v143, v175, v183
  v_permlane32_swap_b32 v176, v180
  v_permlane32_swap_b32 v177, v181
  v_permlane32_swap_b32 v178, v182
  v_permlane32_swap_b32 v179, v183
  v_add_f32 v176, v176, v180
  v_add_f32 v177, v177, v181
  v_add_f32 v178, v178, v182
  v_add_f32 v179, v179, v183
  s_nop 0
  v_permlane16_swap_b32 v176, v178
  v_permlane16_swap_b32 v177, v179
  v_add_f32 v176, v176, v178
  v_add_f32 v177, v177, v179
  s_nop 0
  v_add_f32_dpp v184, v176, v176 row_ror:8 row_mask:0xf bank_mask:0x3
  v_add_f32_dpp v184, v177, v177 row_ror:8 row_mask:0xf bank_mask:0xc
  v_mov_b32 v185, s59
  s_cbranch_execz Lg_31
  global_store_dwordx2 v3, v[184:185], s[34:35] sc1
Lg_31:
  s_cmp_lt_u32 s60, 192
  s_cbranch_scc1 L_ch_gemvA_ret
  s_mov_b32 s61, 1
  s_branch L_ch_gemvA
L_ch_gemvA_ret:
  s_lshl_b32 s46, s51, 12
  s_add_u32 s46, s46, 0x19000
  v_add_u32 v3, s46, v2
  s_cbranch_execz Lg_32
  s_mov_b32 s63, 262144
Lp_33:
  s_sub_u32 s63, s63, 1
  s_cbranch_scc1 Lq_34
  s_add_u32 s44, s34, 0
  s_addc_u32 s45, s35, 0
  global_load_dwordx4 v[16:19], v3, s[44:45] offset:0 sc1
  global_load_dwordx4 v[20:23], v3, s[44:45] offset:1024 sc1
  global_load_dwordx4 v[24:27], v3, s[44:45] offset:2048 sc1
  global_load_dwordx4 v[28:31], v3, s[44:45] offset:3072 sc1
  s_add_u32 s44, s34, 32768
  s_addc_u32 s45, s35, 0
  global_load_dwordx4 v[32:35], v3, s[44:45] offset:0 sc1
  global_load_dwordx4 v[36:39], v3, s[44:45] offset:1024 sc1
  global_load_dwordx4 v[40:43], v3, s[44:45] offset:2048 sc1
  global_load_dwordx4 v[44:47], v3, s[44:45] offset:3072 sc1
  s_add_u32 s44, s34, 65536
  s_addc_u32 s45, s35, 0
  global_load_dwordx4 v[48:51], v3, s[44:45] offset:0 sc1
  global_load_dwordx4 v[52:55], v3, s[44:45] offset:1024 sc1
  global_load_dwordx4 v[56:59], v3, s[44:45] offset:2048 sc1
  global_load_dwordx4 v[60:63], v3, s[44:45] offset:3072 sc1
  s_add_u32 s44, s34, 98304
  s_addc_u32 s45, s35, 0
  global_load_dwordx4 v[64:67], v3, s[44:45] offset:0 sc1
  global_load_dwordx4 v[68:71], v3, s[44:45] offset:1024 sc1
  global_load_dwordx4 v[72:75], v3, s[44:45] offset:2048 sc1
  global_load_dwordx4 v[76:79], v3, s[44:45] offset:3072 sc1
  s_waitcnt vmcnt(0)
  v_min3_u32 v184, v17, v19, v21
  v_min3_u32 v184, v184, v23, v25
  v_min3_u32 v184, v184, v27, v29
  v_min3_u32 v184, v184, v31, v33
  v_min3_u32 v184, v184, v35, v37
  v_min3_u32 v184, v184, v39, v41
  v_min3_u32 v184, v184, v43, v45
  v_min3_u32 v184, v184, v47, v49
  v_min3_u32 v184, v184, v51, v53
  v_min3_u32 v184, v184, v55, v57
  v_min3_u32 v184, v184, v59, v61
  v_min3_u32 v184, v184, v63, v65
  v_min3_u32 v184, v184, v67, v69
  v_min3_u32 v184, v184, v71, v73
  v_min3_u32 v184, v184, v75, v77
  v_min_u32 v184, v184, v79
  v_max3_u32 v185, v17, v19, v21
  v_max3_u32 v185, v185, v23, v25
  v_max3_u32 v185, v185, v27, v29
  v_max3_u32 v185, v185, v31, v33
  v_max3_u32 v185, v185, v35, v37
  v_max3_u32 v185, v185, v39, v41
  v_max3_u32 v185, v185, v43, v45
  v_max3_u32 v185, v185, v47, v49
  v_max3_u32 v185, v185, v51, v53
  v_max3_u32 v185, v185, v55, v57
  v_max3_u32 v185, v185, v59, v61
  v_max3_u32 v185, v185, v63, v65
  v_max3_u32 v185, v185, v67, v69
  v_max3_u32 v185, v185, v71, v73
  v_max3_u32 v185, v185, v75, v77
  v_max_u32 v185, v185, v79
  v_cmp_ne_u32 vcc, s59, v184
  v_cmp_ne_u32 s[44:45], s59, v185
  s_nop 0
  s_or_b64 vcc, vcc, s[44:45]
  s_cbranch_vccnz Lp_33
Lq_34:
Lg_32:
  v_add_f32 v16, v16, v32
  v_add_f32 v48, v48, v64
  v_add_f32 v18, v18, v34
  v_add_f32 v50, v50, v66
  v_add_f32 v20, v20, v36
  v_add_f32 v52, v52, v68
  v_add_f32 v22, v22, v38
  v_add_f32 v54, v54, v70
  v_add_f32 v24, v24, v40
  v_add_f32 v56, v56, v72
  v_add_f32 v26, v26, v42
  v_add_f32 v58, v58, v74
  v_add_f32 v28, v28, v44
  v_add_f32 v60, v60, v76
  v_add_f32 v30, v30, v46
  v_add_f32 v62, v62, v78
  v_add_f32 v16, v16, v48
  v_add_f32 v18, v18, v50
  v_add_f32 v20, v20, v52
  v_add_f32 v22, v22, v54
  v_add_f32 v24, v24, v56
  v_add_f32 v26, v26, v58
  v_add_f32 v28, v28, v60
  v_add_f32 v30, v30, v62
  v_cvt_pk_bf16_f32 v16, v16, v18
  v_cvt_pk_bf16_f32 v20, v20, v22
  v_cvt_pk_bf16_f32 v24, v24, v26
  v_cvt_pk_bf16_f32 v28, v28, v30
  ds_write_b32 v13, v16 offset:512
  ds_write_b32 v13, v20 offset:768
  ds_write_b32 v13, v24 offset:1024
  ds_write_b32 v13, v28 offset:1280
  v_mov_b32 v3, 1
  s_waitcnt lgkmcnt(0)
  ds_write_b32 v1, v3 offset:0
  s_setprio 0
  v_lshrrev_b32 v14, 5, v0
  s_lshl_b32 s46, s51, 2
  v_add_u32 v15, s46, v14
  s_movk_i32 s46, 14336
  v_mul_lo_u32 v80, v15, s46
  v_and_b32 v3, 31, v0
  v_lshl_add_u32 v80, v3, 4, v80
  s_lshl_b32 s46, s52, 9
  s_add_u32 s46, s46, 0x5e000
  v_add_u32 v80, s46, v80
  v_add_u32 v81, 28672, v80
  v_lshlrev_b32 v82, 9, v15
  s_lshl_b32 s46, s52, 4
  s_add_u32 s46, s46, 0x39000
  v_add_u32 v82, s46, v82
  v_lshlrev_b32 v14, 6, v14
  s_mov_b32 s63, 262144
  s_nop 0
Lp_35:
  s_sub_u32 s63, s63, 1
  s_cbranch_scc1 Lq_36
  s_sleep 1
  ds_read_b128 v[160:163], v14 offset:64
  ds_read_b128 v[164:167], v14 offset:80
  ds_read_b128 v[168:171], v14 offset:96
  ds_read_b128 v[172:175], v14 offset:112
  ds_read_b128 v[176:179], v14 offset:192
  ds_read_b128 v[180:183], v14 offset:208
  ds_read_b128 v[184:187], v14 offset:224
  ds_read_b128 v[188:191], v14 offset:240
  s_waitcnt lgkmcnt(0)
  v_min3_f32 v3, v161, v163, v165
  v_min3_f32 v3, v3, v167, v169
  v_min3_f32 v3, v3, v171, v173
  v_min3_f32 v3, v3, v177, v179
  v_min3_f32 v3, v3, v181, v183
  v_min3_f32 v3, v3, v185, v187
  v_min_f32 v3, v3, v189
  v_cmp_ngt_f32 vcc, v3, 0
  s_cbranch_vccnz Lp_35
Lq_36:
  s_mov_b32 s46, 0x3fb8aa3b
  v_max3_f32 v84, v160, v162, v164
  v_max3_f32 v84, v84, v166, v168
  v_max3_f32 v84, v84, v170, v172
  v_sub_f32 v64, v160, v84
  v_sub_f32 v65, v162, v84
  v_sub_f32 v66, v164, v84
  v_sub_f32 v67, v166, v84
  v_sub_f32 v68, v168, v84
  v_sub_f32 v69, v170, v84
  v_sub_f32 v70, v172, v84
  v_mul_f32 v64, s46, v64
  v_mul_f32 v65, s46, v65
  v_mul_f32 v66, s46, v66
  v_mul_f32 v67, s46, v67
  v_mul_f32 v68, s46, v68
  v_mul_f32 v69, s46, v69
  v_mul_f32 v70, s46, v70
  v_exp_f32 v64, v64
  v_exp_f32 v65, v65
  v_exp_f32 v66, v66
  v_exp_f32 v67, v67
  v_exp_f32 v68, v68
  v_exp_f32 v69, v69
  v_exp_f32 v70, v70
  v_mul_f32 v85, v64, v161
  v_fmac_f32 v85, v65, v163
  v_fmac_f32 v85, v66, v165
  v_fmac_f32 v85, v67, v167
  v_fmac_f32 v85, v68, v169
  v_fmac_f32 v85, v69, v171
  v_fmac_f32 v85, v70, v173
  v_mov_b32 v86, s59
  v_mov_b32 v87, 0
  v_max3_f32 v88, v176, v178, v180
  v_max3_f32 v88, v88, v182, v184
  v_max3_f32 v88, v88, v186, v188
  v_sub_f32 v71, v176, v88
  v_sub_f32 v72, v178, v88
  v_sub_f32 v73, v180, v88
  v_sub_f32 v74, v182, v88
  v_sub_f32 v75, v184, v88
  v_sub_f32 v76, v186, v88
  v_sub_f32 v77, v188, v88
  v_mul_f32 v71, s46, v71
  v_mul_f32 v72, s46, v72
  v_mul_f32 v73, s46, v73
  v_mul_f32 v74, s46, v74
  v_mul_f32 v75, s46, v75
  v_mul_f32 v76, s46, v76
  v_mul_f32 v77, s46, v77
  v_exp_f32 v71, v71
  v_exp_f32 v72, v72
  v_exp_f32 v73, v73
  v_exp_f32 v74, v74
  v_exp_f32 v75, v75
  v_exp_f32 v76, v76
  v_exp_f32 v77, v77
  v_mul_f32 v89, v71, v177
  v_fmac_f32 v89, v72, v179
  v_fmac_f32 v89, v73, v181
  v_fmac_f32 v89, v74, v183
  v_fmac_f32 v89, v75, v185
  v_fmac_f32 v89, v76, v187
  v_fmac_f32 v89, v77, v189
  v_mov_b32 v90, s59
  v_mov_b32 v91, 0
  s_cbranch_execz Lg_37
  s_mov_b32 exec_lo, 1
  s_mov_b32 exec_hi, 1
  global_store_dwordx4 v82, v[84:87], s[34:35] sc1
  global_store_dwordx4 v82, v[88:91], s[34:35] offset:1024 sc1
  s_mov_b64 exec, -1
  s_setprio 3
  s_barrier
Lg_37:
  ds_read_b128 v[96:99], v2 offset:2048
  ds_read_b128 v[100:103], v2 offset:4096
  ds_read_b128 v[104:107], v2 offset:6144
  ds_read_b128 v[108:111], v2 offset:8192
  ds_read_b128 v[112:115], v2 offset:10240
  ds_read_b128 v[116:119], v2 offset:12288
  ds_read_b128 v[120:123], v2 offset:14336
  ds_read_b128 v[124:127], v2 offset:3072
  ds_read_b128 v[128:131], v2 offset:5120
  ds_read_b128 v[132:135], v2 offset:7168
  ds_read_b128 v[136:139], v2 offset:9216
  ds_read_b128 v[140:143], v2 offset:11264
  ds_read_b128 v[144:147], v2 offset:13312
  ds_read_b128 v[148:151], v2 offset:15360
  s_waitcnt lgkmcnt(7)
  v_mul_f32 v96, v96, v64
  v_mul_f32 v97, v97, v64
  v_mul_f32 v98, v98, v64
  v_mul_f32 v99, v99, v64
  v_mul_f32 v100, v100, v65
  v_mul_f32 v101, v101, v65
  v_mul_f32 v102, v102, v65
  v_mul_f32 v103, v103, v65
  v_fmac_f32 v96, v104, v66
  v_fmac_f32 v97, v105, v66
  v_fmac_f32 v98, v106, v66
  v_fmac_f32 v99, v107, v66
  v_fmac_f32 v100, v108, v67
  v_fmac_f32 v101, v109, v67
  v_fmac_f32 v102, v110, v67
  v_fmac_f32 v103, v111, v67
  v_fmac_f32 v96, v112, v68
  v_fmac_f32 v97, v113, v68
  v_fmac_f32 v98, v114, v68
  v_fmac_f32 v99, v115, v68
  v_fmac_f32 v100, v116, v69
  v_fmac_f32 v101, v117, v69
  v_fmac_f32 v102, v118, v69
  v_fmac_f32 v103, v119, v69
  v_fmac_f32 v96, v120, v70
  v_fmac_f32 v97, v121, v70
  v_fmac_f32 v98, v122, v70
  v_fmac_f32 v99, v123, v70
  v_add_f32 v96, v96, v100
  v_add_f32 v97, v97, v101
  v_add_f32 v98, v98, v102
  v_add_f32 v99, v99, v103
  s_cbranch_execz Lg_38
  global_store_dwordx4 v80, v[96:99], s[34:35] sc1
Lg_38:
  s_waitcnt lgkmcnt(0)
  v_mul_f32 v124, v124, v71
  v_mul_f32 v125, v125, v71
  v_mul_f32 v126, v126, v71
  v_mul_f32 v127, v127, v71
  v_mul_f32 v128, v128, v72
  v_mul_f32 v129, v129, v72
  v_mul_f32 v130, v130, v72
  v_mul_f32 v131, v131, v72
  v_fmac_f32 v124, v132, v73
  v_fmac_f32 v125, v133, v73
  v_fmac_f32 v126, v134, v73
  v_fmac_f32 v127, v135, v73
  v_fmac_f32 v128, v136, v74
  v_fmac_f32 v129, v137, v74
  v_fmac_f32 v130, v138, v74
  v_fmac_f32 v131, v139, v74
  v_fmac_f32 v124, v140, v75
  v_fmac_f32 v125, v141, v75
  v_fmac_f32 v126, v142, v75
  v_fmac_f32 v127, v143, v75
  v_fmac_f32 v128, v144, v76
  v_fmac_f32 v129, v145, v76
  v_fmac_f32 v130, v146, v76
  v_fmac_f32 v131, v147, v76
  v_fmac_f32 v124, v148, v77
  v_fmac_f32 v125, v149, v77
  v_fmac_f32 v126, v150, v77
  v_fmac_f32 v127, v151, v77
  v_add_f32 v124, v124, v128
  v_add_f32 v125, v125, v129
  v_add_f32 v126, v126, v130
  v_add_f32 v127, v127, v131
  s_cbranch_execz Lg_39
  global_store_dwordx4 v81, v[124:127], s[34:35] sc1
Lg_39:
  s_cbranch_execz Lg_40
  s_branch L_done
Lg_40:
.p2align 6
L_tail_compute:
  v_mov_b32 v216, 0
  v_mov_b32 v217, 0
  v_mov_b32 v218, 0
  v_mov_b32 v219, 0
  v_mov_b32 v220, 0
  v_mov_b32 v221, 0
  v_mov_b32 v222, 0
  v_mov_b32 v223, 0
  s_cbranch_execz Lg_41
  s_cmp_eq_u32 s75, 0
  s_cbranch_scc1 L_t_s1done
Lg_41:
  v_mov_b32 v212, 0xff800000
  v_mov_b32 v213, 0
  v_mov_b32 v214, s59
  s_cbranch_execz Lg_42
  s_mov_b32 s63, 262144
Lp_43:
  s_sub_u32 s63, s63, 1
  s_cbranch_scc1 Lq_44
  s_sleep 2
  global_load_dwordx4 v[208:211], v185, s[34:35] sc1
  s_mov_b32 exec_hi, 0xffff
  global_load_dwordx4 v[212:215], v185, s[34:35] offset:256 sc1
  s_mov_b64 exec, -1
  s_waitcnt vmcnt(0)
  v_cmp_ne_u32 vcc, s59, v210
  v_cmp_ne_u32 s[44:45], s59, v214
  s_nop 0
  s_or_b64 vcc, vcc, s[44:45]
  s_cbranch_vccnz Lp_43
Lq_44:
Lg_42:
  v_max_f32 v232, v208, v212
  s_nop 1
  v_max_f32_dpp v232, v232, v232 row_ror:8 row_mask:0xf bank_mask:0xf
  s_nop 1
  v_max_f32_dpp v232, v232, v232 row_ror:4 row_mask:0xf bank_mask:0xf
  v_mov_b32 v235, v232
  s_nop 1
  v_permlane16_swap_b32 v232, v235
  v_max_f32 v232, v232, v235
  v_mov_b32 v235, v232
  s_nop 1
  v_permlane32_swap_b32 v232, v235
  v_max_f32 v232, v232, v235
  s_mov_b32 s46, 0x3fb8aa3b
  v_sub_f32 v8, v208, v232
  v_sub_f32 v9, v212, v232
  v_mul_f32 v8, s46, v8
  v_mul_f32 v9, s46, v9
  v_exp_f32 v8, v8
  v_exp_f32 v9, v9
  v_mul_f32 v232, v8, v209
  v_fmac_f32 v232, v9, v213
  s_nop 1
  v_add_f32_dpp v232, v232, v232 row_ror:8 row_mask:0xf bank_mask:0xf
  s_nop 1
  v_add_f32_dpp v232, v232, v232 row_ror:4 row_mask:0xf bank_mask:0xf
  v_mov_b32 v235, v232
  s_nop 1
  v_permlane16_swap_b32 v232, v235
  v_add_f32 v232, v232, v235
  v_mov_b32 v235, v232
  s_nop 1
  v_permlane32_swap_b32 v232, v235
  v_add_f32 v232, v232, v235
  v_rcp_f32 v235, v232
  s_nop 0
  v_fma_f32 v232, -v232, v235, 1.0
  v_fma_f32 v235, v232, v235, v235
  v_mul_f32 v8, v8, v235
  v_mul_f32 v9, v9, v235
  s_cbranch_execz Lg_45
  s_cmp_eq_u32 s76, 0
  s_cbranch_scc1 L_t_s1a
Lg_45:
  v_mov_b32 v212, 0xff800000
  v_mov_b32 v213, 0
  v_mov_b32 v214, s59
  s_cbranch_execz Lg_46
  s_mov_b32 s63, 262144
Lp_47:
  s_sub_u32 s63, s63, 1
  s_cbranch_scc1 Lq_48
  s_sleep 2
  global_load_dwordx4 v[208:211], v6, s[34:35] sc1
  s_mov_b32 exec_hi, 0xffff
  global_load_dwordx4 v[212:215], v6, s[34:35] offset:256 sc1
  s_mov_b64 exec, -1
  s_waitcnt vmcnt(0)
  v_cmp_ne_u32 vcc, s59, v210
  v_cmp_ne_u32 s[44:45], s59, v214
  s_nop 0
  s_or_b64 vcc, vcc, s[44:45]
  s_cbranch_vccnz Lp_47
Lq_48:
Lg_46:
  v_max_f32 v232, v208, v212
  s_nop 1
  v_max_f32_dpp v232, v232, v232 row_ror:8 row_mask:0xf bank_mask:0xf
  s_nop 1
  v_max_f32_dpp v232, v232, v232 row_ror:4 row_mask:0xf bank_mask:0xf
  v_mov_b32 v235, v232
  s_nop 1
  v_permlane16_swap_b32 v232, v235
  v_max_f32 v232, v232, v235
  v_mov_b32 v235, v232
  s_nop 1
  v_permlane32_swap_b32 v232, v235
  v_max_f32 v232, v232, v235
  s_mov_b32 s46, 0x3fb8aa3b
  v_sub_f32 v10, v208, v232
  v_sub_f32 v11, v212, v232
  v_mul_f32 v10, s46, v10
  v_mul_f32 v11, s46, v11
  v_exp_f32 v10, v10
  v_exp_f32 v11, v11
  v_mul_f32 v232, v10, v209
  v_fmac_f32 v232, v11, v213
  s_nop 1
  v_add_f32_dpp v232, v232, v232 row_ror:8 row_mask:0xf bank_mask:0xf
  s_nop 1
  v_add_f32_dpp v232, v232, v232 row_ror:4 row_mask:0xf bank_mask:0xf
  v_mov_b32 v235, v232
  s_nop 1
  v_permlane16_swap_b32 v232, v235
  v_add_f32 v232, v232, v235
  v_mov_b32 v235, v232
  s_nop 1
  v_permlane32_swap_b32 v232, v235
  v_add_f32 v232, v232, v235
  v_rcp_f32 v235, v232
  s_nop 0
  v_fma_f32 v232, -v232, v235, 1.0
  v_fma_f32 v235, v232, v235, v235
  v_mul_f32 v10, v10, v235
  v_mul_f32 v11, v11, v235
  v_mov_b32 v204, 0
  v_mov_b32 v205, 0
  v_mov_b32 v206, 0
  v_mov_b32 v207, 0
  v_mov_b32 v212, 0
  v_mov_b32 v213, 0
  v_mov_b32 v214, 0
  v_mov_b32 v215, 0
  s_cbranch_execz Lg_49
  s_mov_b32 s63, 262144
Lp_50:
  s_sub_u32 s63, s63, 1
  s_cbranch_scc1 Lq_51
  global_load_dwordx4 v[200:203], v183, s[34:35] sc1
  global_load_dwordx4 v[208:211], v4, s[34:35] sc1
  s_mov_b32 exec_hi, 0xffff
  global_load_dwordx4 v[204:207], v184, s[34:35] sc1
  global_load_dwordx4 v[212:215], v5, s[34:35] sc1
  s_mov_b64 exec, -1
  s_waitcnt vmcnt(0)
  v_max3_u32 v232, v200, v201, v202
  v_max3_u32 v232, v232, v203, v204
  v_max3_u32 v232, v232, v205, v206
  v_max3_u32 v232, v232, v207, v208
  v_max3_u32 v232, v232, v209, v210
  v_max3_u32 v232, v232, v211, v212
  v_max3_u32 v232, v232, v213, v214
  v_max_u32 v232, v232, v215
  v_cmp_eq_u32 vcc, -1, v232
  s_cbranch_vccnz Lp_50
Lq_51:
Lg_49:
  v_mul_f32 v208, v10, v208
  v_mul_f32 v209, v10, v209
  v_mul_f32 v210, v10, v210
  v_mul_f32 v211, v10, v211
  v_fmac_f32 v208, v11, v212
  v_fmac_f32 v209, v11, v213
  v_fmac_f32 v210, v11, v214
  v_fmac_f32 v211, v11, v215
  s_nop 0
  v_permlane32_swap_b32 v208, v210
  v_permlane32_swap_b32 v209, v211
  v_add_f32 v208, v208, v210
  v_add_f32 v209, v209, v211
  s_nop 1
  v_permlane16_swap_b32 v208, v209
  v_add_f32 v208, v208, v209
  s_nop 1
  v_add_f32_dpp v208, v208, v208 row_ror:8 row_mask:0xf bank_mask:0xf
  s_nop 1
  v_add_f32_dpp v208, v208, v208 row_ror:4 row_mask:0xf bank_mask:0xf
  v_mov_b32 v235, v208
  s_nop 1
  v_permlane16_swap_b32 v208, v235
  v_cvt_pk_bf16_f32 v208, v208, v235
  s_nop 0
  v_readlane_b32 s64, v208, 0
  v_readlane_b32 s65, v208, 32
  v_readlane_b32 s66, v208, 1
  v_readlane_b32 s67, v208, 33
  v_readlane_b32 s68, v208, 2
  v_readlane_b32 s69, v208, 34
  v_readlane_b32 s70, v208, 3
  v_readlane_b32 s71, v208, 35
  v_dot2_f32_bf16 v216, v75, s64, v216
  v_dot2_f32_bf16 v217, v84, s64, v217
  v_dot2_f32_bf16 v218, v80, s64, v218
  v_dot2_f32_bf16 v219, v85, s64, v219
  v_dot2_f32_bf16 v220, v81, s64, v220
  v_dot2_f32_bf16 v221, v86, s64, v221
  v_dot2_f32_bf16 v222, v82, s64, v222
  v_dot2_f32_bf16 v223, v87, s64, v223
  v_dot2_f32_bf16 v216, v83, s65, v216
  v_dot2_f32_bf16 v217, v92, s65, v217
  v_dot2_f32_bf16 v218, v88, s65, v218
  v_dot2_f32_bf16 v219, v93, s65, v219
  v_dot2_f32_bf16 v220, v89, s65, v220
  v_dot2_f32_bf16 v221, v94, s65, v221
  v_dot2_f32_bf16 v222, v90, s65, v222
  v_dot2_f32_bf16 v223, v95, s65, v223
  v_dot2_f32_bf16 v216, v91, s66, v216
  v_dot2_f32_bf16 v217, v100, s66, v217
  v_dot2_f32_bf16 v218, v96, s66, v218
  v_dot2_f32_bf16 v219, v101, s66, v219
  v_dot2_f32_bf16 v220, v97, s66, v220
  v_dot2_f32_bf16 v221, v102, s66, v221
  v_dot2_f32_bf16 v222, v98, s66, v222
  v_dot2_f32_bf16 v223, v103, s66, v223
  v_dot2_f32_bf16 v216, v99, s67, v216
  v_dot2_f32_bf16 v217, v108, s67, v217
  v_dot2_f32_bf16 v218, v104, s67, v218
  v_dot2_f32_bf16 v219, v109, s67, v219
  v_dot2_f32_bf16 v220, v105, s67, v220
  v_dot2_f32_bf16 v221, v110, s67, v221
  v_dot2_f32_bf16 v222, v106, s67, v222
  v_dot2_f32_bf16 v223, v111, s67, v223
  v_dot2_f32_bf16 v216, v107, s68, v216
  v_dot2_f32_bf16 v217, v116, s68, v217
  v_dot2_f32_bf16 v218, v112, s68, v218
  v_dot2_f32_bf16 v219, v117, s68, v219
  v_dot2_f32_bf16 v220, v113, s68, v220
  v_dot2_f32_bf16 v221, v118, s68, v221
  v_dot2_f32_bf16 v222, v114, s68, v222
  v_dot2_f32_bf16 v223, v119, s68, v223
  v_dot2_f32_bf16 v216, v115, s69, v216
  v_dot2_f32_bf16 v217, v124, s69, v217
  v_dot2_f32_bf16 v218, v120, s69, v218
  v_dot2_f32_bf16 v219, v125, s69, v219
  v_dot2_f32_bf16 v220, v121, s69, v220
  v_dot2_f32_bf16 v221, v126, s69, v221
  v_dot2_f32_bf16 v222, v122, s69, v222
  v_dot2_f32_bf16 v223, v127, s69, v223
  v_dot2_f32_bf16 v216, v123, s70, v216
  v_dot2_f32_bf16 v217, v132, s70, v217
  v_dot2_f32_bf16 v218, v128, s70, v218
  v_dot2_f32_bf16 v219, v133, s70, v219
  v_dot2_f32_bf16 v220, v129, s70, v220
  v_dot2_f32_bf16 v221, v134, s70, v221
  v_dot2_f32_bf16 v222, v130, s70, v222
  v_dot2_f32_bf16 v223, v135, s70, v223
  v_dot2_f32_bf16 v216, v131, s71, v216
  v_dot2_f32_bf16 v217, v140, s71, v217
  v_dot2_f32_bf16 v218, v136, s71, v218
  v_dot2_f32_bf16 v219, v141, s71, v219
  v_dot2_f32_bf16 v220, v137, s71, v220
  v_dot2_f32_bf16 v221, v142, s71, v221
  v_dot2_f32_bf16 v222, v138, s71, v222
  v_dot2_f32_bf16 v223, v143, s71, v223
  s_nop 2
  s_cbranch_execz Lg_52
  s_branch L_t_s1b
Lg_52:
L_t_s1a:
  v_mov_b32 v204, 0
  v_mov_b32 v205, 0
  v_mov_b32 v206, 0
  v_mov_b32 v207, 0
  s_cbranch_execz Lg_53
  s_mov_b32 s63, 262144
Lp_54:
  s_sub_u32 s63, s63, 1
  s_cbranch_scc1 Lq_55
  global_load_dwordx4 v[200:203], v183, s[34:35] sc1
  s_mov_b32 exec_hi, 0xffff
  global_load_dwordx4 v[204:207], v184, s[34:35] sc1
  s_mov_b64 exec, -1
  s_waitcnt vmcnt(0)
  v_max3_u32 v232, v200, v201, v202
  v_max3_u32 v232, v232, v203, v204
  v_max3_u32 v232, v232, v205, v206
  v_max_u32 v232, v232, v207
  v_cmp_eq_u32 vcc, -1, v232
  s_cbranch_vccnz Lp_54
Lq_55:
Lg_53:
  s_nop 3
L_t_s1b:
  v_mul_f32 v200, v8, v200
  v_mul_f32 v201, v8, v201
  v_mul_f32 v202, v8, v202
  v_mul_f32 v203, v8, v203
  v_fmac_f32 v200, v9, v204
  v_fmac_f32 v201, v9, v205
  v_fmac_f32 v202, v9, v206
  v_fmac_f32 v203, v9, v207
  s_nop 0
  v_permlane32_swap_b32 v200, v202
  v_permlane32_swap_b32 v201, v203
  v_add_f32 v200, v200, v202
  v_add_f32 v201, v201, v203
  s_nop 1
  v_permlane16_swap_b32 v200, v201
  v_add_f32 v200, v200, v201
  s_nop 1
  v_add_f32_dpp v200, v200, v200 row_ror:8 row_mask:0xf bank_mask:0xf
  s_nop 1
  v_add_f32_dpp v200, v200, v200 row_ror:4 row_mask:0xf bank_mask:0xf
  v_mov_b32 v235, v200
  s_nop 1
  v_permlane16_swap_b32 v200, v235
  v_cvt_pk_bf16_f32 v200, v200, v235
  s_nop 0
  v_readlane_b32 s64, v200, 0
  v_readlane_b32 s65, v200, 32
  v_readlane_b32 s66, v200, 1
  v_readlane_b32 s67, v200, 33
  v_readlane_b32 s68, v200, 2
  v_readlane_b32 s69, v200, 34
  v_readlane_b32 s70, v200, 3
  v_readlane_b32 s71, v200, 35
  v_dot2_f32_bf16 v216, v176, s64, v216
  v_dot2_f32_bf16 v217, v20, s64, v217
  v_dot2_f32_bf16 v218, v16, s64, v218
  v_dot2_f32_bf16 v219, v21, s64, v219
  v_dot2_f32_bf16 v220, v17, s64, v220
  v_dot2_f32_bf16 v221, v22, s64, v221
  v_dot2_f32_bf16 v222, v18, s64, v222
  v_dot2_f32_bf16 v223, v23, s64, v223
  v_dot2_f32_bf16 v216, v19, s65, v216
  v_dot2_f32_bf16 v217, v28, s65, v217
  v_dot2_f32_bf16 v218, v24, s65, v218
  v_dot2_f32_bf16 v219, v29, s65, v219
  v_dot2_f32_bf16 v220, v25, s65, v220
  v_dot2_f32_bf16 v221, v30, s65, v221
  v_dot2_f32_bf16 v222, v26, s65, v222
  v_dot2_f32_bf16 v223, v31, s65, v223
  v_dot2_f32_bf16 v216, v27, s66, v216
  v_dot2_f32_bf16 v217, v36, s66, v217
  v_dot2_f32_bf16 v218, v32, s66, v218
  v_dot2_f32_bf16 v219, v37, s66, v219
  v_dot2_f32_bf16 v220, v33, s66, v220
  v_dot2_f32_bf16 v221, v38, s66, v221
  v_dot2_f32_bf16 v222, v34, s66, v222
  v_dot2_f32_bf16 v223, v39, s66, v223
  v_dot2_f32_bf16 v216, v35, s67, v216
  v_dot2_f32_bf16 v217, v44, s67, v217
  v_dot2_f32_bf16 v218, v40, s67, v218
  v_dot2_f32_bf16 v219, v45, s67, v219
  v_dot2_f32_bf16 v220, v41, s67, v220
  v_dot2_f32_bf16 v221, v46, s67, v221
  v_dot2_f32_bf16 v222, v42, s67, v222
  v_dot2_f32_bf16 v223, v47, s67, v223
  v_dot2_f32_bf16 v216, v43, s68, v216
  v_dot2_f32_bf16 v217, v52, s68, v217
  v_dot2_f32_bf16 v218, v48, s68, v218
  v_dot2_f32_bf16 v219, v53, s68, v219
  v_dot2_f32_bf16 v220, v49, s68, v220
  v_dot2_f32_bf16 v221, v54, s68, v221
  v_dot2_f32_bf16 v222, v50, s68, v222
  v_dot2_f32_bf16 v223, v55, s68, v223
  v_dot2_f32_bf16 v216, v51, s69, v216
  v_dot2_f32_bf16 v217, v60, s69, v217
  v_dot2_f32_bf16 v218, v56, s69, v218
  v_dot2_f32_bf16 v219, v61, s69, v219
  v_dot2_f32_bf16 v220, v57, s69, v220
  v_dot2_f32_bf16 v221, v62, s69, v221
  v_dot2_f32_bf16 v222, v58, s69, v222
  v_dot2_f32_bf16 v223, v63, s69, v223
  v_dot2_f32_bf16 v216, v59, s70, v216
  v_dot2_f32_bf16 v217, v68, s70, v217
  v_dot2_f32_bf16 v218, v64, s70, v218
  v_dot2_f32_bf16 v219, v69, s70, v219
  v_dot2_f32_bf16 v220, v65, s70, v220
  v_dot2_f32_bf16 v221, v70, s70, v221
  v_dot2_f32_bf16 v222, v66, s70, v222
  v_dot2_f32_bf16 v223, v71, s70, v223
  v_dot2_f32_bf16 v216, v67, s71, v216
  v_dot2_f32_bf16 v217, v76, s71, v217
  v_dot2_f32_bf16 v218, v72, s71, v218
  v_dot2_f32_bf16 v219, v77, s71, v219
  v_dot2_f32_bf16 v220, v73, s71, v220
  v_dot2_f32_bf16 v221, v78, s71, v221
  v_dot2_f32_bf16 v222, v74, s71, v222
  v_dot2_f32_bf16 v223, v79, s71, v223
  s_nop 2
L_t_s1done:
  ds_write_b128 v194, v[216:219] offset:2048
  ds_write_b128 v194, v[220:223] offset:2064
  s_cbranch_execz Lg_56
  s_waitcnt lgkmcnt(0)
  s_barrier
  s_cmp_gt_u32 s3, 1
  s_cbranch_scc1 L_t_s3
Lg_56:
  ds_read_b128 v[200:203], v195 offset:2048
  ds_read_b128 v[204:207], v195 offset:4096
  ds_read_b128 v[208:211], v195 offset:6144
  ds_read_b128 v[212:215], v195 offset:8192
  ds_read_b128 v[216:219], v195 offset:10240
  ds_read_b128 v[220:223], v195 offset:12288
  ds_read_b128 v[224:227], v195 offset:14336
  ds_read_b128 v[228:231], v195 offset:16384
  v_add_u32 v235, 0x3e000, v191
  s_waitcnt lgkmcnt(0)
  v_add_f32 v200, v200, v204
  v_add_f32 v201, v201, v205
  v_add_f32 v202, v202, v206
  v_add_f32 v203, v203, v207
  v_add_f32 v208, v208, v212
  v_add_f32 v209, v209, v213
  v_add_f32 v210, v210, v214
  v_add_f32 v211, v211, v215
  v_add_f32 v216, v216, v220
  v_add_f32 v217, v217, v221
  v_add_f32 v218, v218, v222
  v_add_f32 v219, v219, v223
  v_add_f32 v224, v224, v228
  v_add_f32 v225, v225, v229
  v_add_f32 v226, v226, v230
  v_add_f32 v227, v227, v231
  v_add_f32 v200, v200, v208
  v_add_f32 v201, v201, v209
  v_add_f32 v202, v202, v210
  v_add_f32 v203, v203, v211
  v_add_f32 v216, v216, v224
  v_add_f32 v217, v217, v225
  v_add_f32 v218, v218, v226
  v_add_f32 v219, v219, v227
  v_add_f32 v200, v200, v216
  v_add_f32 v201, v201, v217
  v_add_f32 v202, v202, v218
  v_add_f32 v203, v203, v219
  s_cbranch_execz Lg_57
  s_nop 0
  s_cmp_lg_u32 s62, 0
  s_cbranch_scc1 Ls_58
  global_store_dwordx4 v235, v[200:203], s[34:35] sc1
  s_branch Ls_59
Ls_58:
  global_store_dwordx4 v235, v[200:203], s[34:35]
Ls_59:
  s_nop 1
Lg_57:
  s_cbranch_execz Lg_60
  s_cmp_lg_u32 s3, 0
  s_cbranch_scc1 L_t_s3
Lg_60:
  v_add_u32 v235, 0x3e000, v186
  s_cbranch_execz Lg_61
  s_mov_b32 s63, 262144
Lp_62:
  s_sub_u32 s63, s63, 1
  s_cbranch_scc1 Lq_63
  global_load_dwordx4 v[200:203], v235, s[34:35] sc1
  global_load_dwordx4 v[204:207], v235, s[34:35] offset:1024 sc1
  s_waitcnt vmcnt(0)
  v_max3_u32 v232, v200, v201, v202
  v_max3_u32 v232, v232, v203, v204
  v_max3_u32 v232, v232, v205, v206
  v_max_u32 v232, v232, v207
  v_cmp_eq_u32 vcc, -1, v232
  s_cbranch_vccnz Lp_62
Lq_63:
Lg_61:
  v_add_f32 v200, v200, v204
  v_add_f32 v201, v201, v205
  v_add_f32 v202, v202, v206
  v_add_f32 v203, v203, v207
  s_nop 0
  v_permlane32_swap_b32 v200, v202
  v_permlane32_swap_b32 v201, v203
  v_add_f32 v200, v200, v202
  v_add_f32 v201, v201, v203
  s_nop 1
  v_permlane16_swap_b32 v200, v201
  v_add_f32 v200, v200, v201
  s_nop 1
  v_add_f32_dpp v200, v200, v200 row_ror:8 row_mask:0xf bank_mask:0xf
  s_nop 1
  v_add_f32_dpp v200, v200, v200 row_ror:4 row_mask:0xf bank_mask:0xf
  v_cvt_pk_bf16_f32 v200, v200, v200
  v_lshlrev_b32 v200, 16, v200
  v_mul_f32 v200, v200, v179
  v_cvt_pk_bf16_f32 v200, v200, v200
  v_lshlrev_b32 v200, 16, v200
  v_add_f32 v200, v200, v181
  v_cvt_pk_bf16_f32 v182, v200, v200
  v_lshlrev_b32 v182, 16, v182
  s_cbranch_execz Lg_64
  s_and_b32 exec_lo, s6, 0xf000f
  s_and_b32 exec_hi, s7, 0xf000f
  s_cmp_lg_u32 s62, 0
  s_cbranch_scc1 Ls_65
  global_store_dword v193, v182, s[34:35] sc1
  s_branch Ls_66
Ls_65:
  global_store_dword v193, v182, s[34:35]
Ls_66:
  s_nop 1
  s_cmp_lg_u32 s53, 0
  s_cbranch_scc1 L_t_nonN
  v_mov_b32 v235, s59
  s_mov_b64 exec, 1
  global_store_dword v1, v235, s[34:35] offset:0 sc1
L_t_nonN:
  s_mov_b64 exec, s[6:7]
Lg_64:
L_t_s3:
  s_cbranch_execz Lg_67
  s_cmp_ge_u32 s53, 28
  s_cbranch_scc1 L_t_s4
Lg_67:
  s_cbranch_execz Lg_68
  s_mov_b32 s63, 262144
Lp_69:
  s_sub_u32 s63, s63, 1
  s_cbranch_scc1 Lq_70
  global_load_dword v208, v188, s[34:35] sc1
  s_waitcnt vmcnt(0)
  v_cmp_eq_u32 vcc, -1, v208
  s_cbranch_vccnz Lp_69
Lq_70:
Lg_68:
  v_mul_f32 v240, v208, v208
  v_mov_b32 v241, v208
  v_mul_f32 v208, v208, v177
  s_nop 1
  v_mov_b32_dpp v232, v208 quad_perm:[1,1,3,3] row_mask:0xf bank_mask:0xf
  v_cvt_pk_bf16_f32 v232, v208, v232
  s_nop 1
  v_mov_b32_dpp v200, v232 quad_perm:[0,0,0,0] row_mask:0xf bank_mask:0xf
  v_mov_b32_dpp v201, v232 quad_perm:[2,2,2,2] row_mask:0xf bank_mask:0xf
  s_nop 0
  v_mov_b32_dpp v202, v200 row_half_mirror row_mask:0xf bank_mask:0xf
  v_mov_b32_dpp v203, v201 row_half_mirror row_mask:0xf bank_mask:0xf
  v_dot2_f32_bf16 v216, v75, v200, 0
  v_dot2_f32_bf16 v217, v84, v200, 0
  v_dot2_f32_bf16 v218, v80, v200, 0
  v_dot2_f32_bf16 v219, v85, v200, 0
  v_permlane32_swap_b32 v241, v240
  v_dot2_f32_bf16 v220, v81, v200, 0
  v_dot2_f32_bf16 v221, v86, v200, 0
  v_dot2_f32_bf16 v222, v82, v200, 0
  v_dot2_f32_bf16 v223, v87, v200, 0
  v_add_f32 v241, v241, v240
  v_dot2_f32_bf16 v224, v107, v200, 0
  v_dot2_f32_bf16 v225, v116, v200, 0
  v_dot2_f32_bf16 v226, v112, v200, 0
  v_dot2_f32_bf16 v227, v117, v200, 0
  v_mov_b32 v242, v241
  v_dot2_f32_bf16 v228, v113, v200, 0
  v_dot2_f32_bf16 v229, v118, v200, 0
  v_dot2_f32_bf16 v230, v114, v200, 0
  v_dot2_f32_bf16 v231, v119, v200, 0
  v_permlane16_swap_b32 v241, v242
  v_dot2_f32_bf16 v216, v83, v201, v216
  v_dot2_f32_bf16 v217, v92, v201, v217
  v_dot2_f32_bf16 v218, v88, v201, v218
  v_dot2_f32_bf16 v219, v93, v201, v219
  v_add_f32 v241, v241, v242
  v_dot2_f32_bf16 v220, v89, v201, v220
  v_dot2_f32_bf16 v221, v94, v201, v221
  v_dot2_f32_bf16 v222, v90, v201, v222
  v_dot2_f32_bf16 v223, v95, v201, v223
  v_add_f32_dpp v241, v241, v241 row_ror:8 row_mask:0xf bank_mask:0xf
  v_dot2_f32_bf16 v224, v115, v201, v224
  v_dot2_f32_bf16 v225, v124, v201, v225
  v_dot2_f32_bf16 v226, v120, v201, v226
  v_dot2_f32_bf16 v227, v125, v201, v227
  v_add_f32_dpp v241, v241, v241 row_ror:4 row_mask:0xf bank_mask:0xf
  v_dot2_f32_bf16 v228, v121, v201, v228
  v_dot2_f32_bf16 v229, v126, v201, v229
  v_dot2_f32_bf16 v230, v122, v201, v230
  v_dot2_f32_bf16 v231, v127, v201, v231
  v_add_f32_dpp v241, v241, v241 quad_perm:[2,3,0,1] row_mask:0xf bank_mask:0xf
  v_dot2_f32_bf16 v216, v91, v202, v216
  v_dot2_f32_bf16 v217, v100, v202, v217
  v_dot2_f32_bf16 v218, v96, v202, v218
  v_dot2_f32_bf16 v219, v101, v202, v219
  v_add_f32_dpp v241, v241, v241 quad_perm:[1,0,3,2] row_mask:0xf bank_mask:0xf
  v_dot2_f32_bf16 v220, v97, v202, v220
  v_dot2_f32_bf16 v221, v102, v202, v221
  v_dot2_f32_bf16 v222, v98, v202, v222
  v_dot2_f32_bf16 v223, v103, v202, v223
  v_lshrrev_b32 v242, 5, v0
  v_dot2_f32_bf16 v224, v123, v202, v224
  v_dot2_f32_bf16 v225, v132, v202, v225
  v_dot2_f32_bf16 v226, v128, v202, v226
  v_dot2_f32_bf16 v227, v133, v202, v227
  v_lshlrev_b32 v242, 5, v242
  v_dot2_f32_bf16 v228, v129, v202, v228
  v_dot2_f32_bf16 v229, v134, v202, v229
  v_dot2_f32_bf16 v230, v130, v202, v230
  v_dot2_f32_bf16 v231, v135, v202, v231
  s_lshl_b32 s46, s3, 2
  v_dot2_f32_bf16 v216, v99, v203, v216
  v_dot2_f32_bf16 v217, v108, v203, v217
  v_dot2_f32_bf16 v218, v104, v203, v218
  v_dot2_f32_bf16 v219, v109, v203, v219
  v_add_u32 v242, s46, v242
  v_dot2_f32_bf16 v220, v105, v203, v220
  v_dot2_f32_bf16 v221, v110, v203, v221
  v_dot2_f32_bf16 v222, v106, v203, v222
  v_dot2_f32_bf16 v223, v111, v203, v223
  v_dot2_f32_bf16 v224, v131, v203, v224
  v_dot2_f32_bf16 v225, v140, v203, v225
  v_dot2_f32_bf16 v226, v136, v203, v226
  v_dot2_f32_bf16 v227, v141, v203, v227
  v_dot2_f32_bf16 v228, v137, v203, v228
  v_dot2_f32_bf16 v229, v142, v203, v229
  v_dot2_f32_bf16 v230, v138, v203, v230
  v_dot2_f32_bf16 v231, v143, v203, v231
  v_permlane32_swap_b32 v216, v224
  v_permlane32_swap_b32 v217, v225
  v_permlane32_swap_b32 v218, v226
  v_permlane32_swap_b32 v219, v227
  v_permlane32_swap_b32 v220, v228
  v_permlane32_swap_b32 v221, v229
  v_permlane32_swap_b32 v222, v230
  v_permlane32_swap_b32 v223, v231
  v_add_f32 v216, v216, v224
  v_add_f32 v217, v217, v225
  v_add_f32 v218, v218, v226
  v_add_f32 v219, v219, v227
  v_add_f32 v220, v220, v228
  v_add_f32 v221, v221, v229
  v_add_f32 v222, v222, v230
  v_add_f32 v223, v223, v231
  v_permlane16_swap_b32 v216, v220
  v_permlane16_swap_b32 v217, v221
  v_permlane16_swap_b32 v218, v222
  v_permlane16_swap_b32 v219, v223
  v_add_f32 v216, v216, v220
  v_add_f32 v217, v217, v221
  v_add_f32 v218, v218, v222
  v_add_f32 v219, v219, v223
  v_add_f32_dpp v232, v216, v216 row_ror:8 row_mask:0xf bank_mask:0x3
  v_add_f32_dpp v232, v218, v218 row_ror:8 row_mask:0xf bank_mask:0xc
  v_add_f32_dpp v233, v217, v217 row_ror:8 row_mask:0xf bank_mask:0x3
  v_add_f32_dpp v233, v219, v219 row_ror:8 row_mask:0xf bank_mask:0xc
  ds_write_b64 v189, v[232:233] offset:18432
  s_and_b32 exec_lo, s6, 0x1
  s_and_b32 exec_hi, s7, 0x1
  ds_write_b32 v242, v241 offset:64
  s_mov_b64 exec, s[6:7]
  s_cbranch_execz Lg_71
  s_waitcnt lgkmcnt(0)
  s_barrier
Lg_71:
  ds_read_b128 v[240:243], v1 offset:64
  ds_read_b128 v[244:247], v1 offset:80
  ds_read_b128 v[248:251], v1 offset:96
  ds_read_b128 v[252:255], v1 offset:112
  ds_read_b32 v232, v190 offset:18432
  ds_read_b32 v233, v190 offset:18688
  s_waitcnt lgkmcnt(2)
  v_add_f32 v240, v240, v241
  v_add_f32 v242, v242, v243
  v_add_f32 v244, v244, v245
  v_add_f32 v246, v246, v247
  v_add_f32 v248, v248, v249
  v_add_f32 v250, v250, v251
  v_add_f32 v252, v252, v253
  v_add_f32 v254, v254, v255
  s_waitcnt lgkmcnt(0)
  v_permlane32_swap_b32 v232, v233
  v_add_f32 v240, v240, v242
  v_add_f32 v244, v244, v246
  v_add_f32 v248, v248, v250
  v_add_f32 v252, v252, v254
  v_add_f32 v232, v232, v233
  v_mov_b32 v235, v232
  v_add_f32 v240, v240, v244
  v_add_f32 v248, v248, v252
  v_permlane16_swap_b32 v232, v235
  v_add_f32 v232, v232, v235
  v_mul_f32 v240, 0x3b000000, v240
  v_mul_f32 v248, 0x3b000000, v248
  v_fma_f32 v248, -v240, v240, v248
  v_add_f32_dpp v232, v232, v232 row_ror:8 row_mask:0xf bank_mask:0xf
  v_max_f32 v248, 0, v248
  v_cvt_pk_bf16_f32 v240, v240, v248
  v_and_b32 v248, 0xffff0000, v240
  v_lshlrev_b32 v240, 16, v240
  v_add_f32 v248, 0x3727c5ac, v248
  v_fma_f32 v232, -v240, v12, v232
  v_cvt_pk_bf16_f32 v248, v248, v248
  v_lshlrev_b32 v248, 16, v248
  v_sqrt_f32 v248, v248
  s_nop 0
  v_cvt_pk_bf16_f32 v248, v248, v248
  v_lshlrev_b32 v248, 16, v248
  v_rcp_f32 v241, v248
  s_nop 0
  v_fma_f32 v232, v232, v241, v13
  v_cvt_pk_bf16_f32 v232, v232, v232
  v_lshlrev_b32 v232, 16, v232
  v_mov_b32 v233, v232
  s_nop 1
  v_permlane32_swap_b32 v232, v233
  v_mul_f32 v235, v232, v232
  v_mov_b32 v236, 0x3d372713
  v_fma_f32 v235, v235, v236, 1.0
  v_mul_f32 v235, v235, v232
  v_mul_f32 v235, 0xc0135761, v235
  v_exp_f32 v235, v235
  s_nop 0
  v_add_f32 v235, 1.0, v235
  v_rcp_f32 v235, v235
  s_nop 0
  v_mul_f32 v232, v232, v235
  v_cvt_pk_bf16_f32 v232, v232, v232
  v_lshlrev_b32 v232, 16, v232
  v_mul_f32 v232, v232, v233
  s_nop 1
  v_mov_b32_dpp v233, v232 quad_perm:[1,1,3,3] row_mask:0xf bank_mask:0xf
  v_cvt_pk_bf16_f32 v232, v232, v233
  s_nop 0
  v_readlane_b32 s64, v232, 0
  v_readlane_b32 s65, v232, 2
  v_readlane_b32 s66, v232, 4
  v_readlane_b32 s67, v232, 6
  v_dot2_f32_bf16 v216, v139, s64, 0
  v_dot2_f32_bf16 v217, v148, s64, 0
  v_dot2_f32_bf16 v218, v144, s64, 0
  v_dot2_f32_bf16 v219, v149, s64, 0
  v_dot2_f32_bf16 v220, v145, s64, 0
  v_dot2_f32_bf16 v221, v150, s64, 0
  v_dot2_f32_bf16 v222, v146, s64, 0
  v_dot2_f32_bf16 v223, v151, s64, 0
  v_dot2_f32_bf16 v216, v147, s65, v216
  v_dot2_f32_bf16 v217, v156, s65, v217
  v_dot2_f32_bf16 v218, v152, s65, v218
  v_dot2_f32_bf16 v219, v157, s65, v219
  v_dot2_f32_bf16 v220, v153, s65, v220
  v_dot2_f32_bf16 v221, v158, s65, v221
  v_dot2_f32_bf16 v222, v154, s65, v222
  v_dot2_f32_bf16 v223, v159, s65, v223
  v_dot2_f32_bf16 v216, v155, s66, v216
  v_dot2_f32_bf16 v217, v164, s66, v217
  v_dot2_f32_bf16 v218, v160, s66, v218
  v_dot2_f32_bf16 v219, v165, s66, v219
  v_dot2_f32_bf16 v220, v161, s66, v220
  v_dot2_f32_bf16 v221, v166, s66, v221
  v_dot2_f32_bf16 v222, v162, s66, v222
  v_dot2_f32_bf16 v223, v167, s66, v223
  v_dot2_f32_bf16 v216, v163, s67, v216
  v_dot2_f32_bf16 v217, v172, s67, v217
  v_dot2_f32_bf16 v218, v168, s67, v218
  v_dot2_f32_bf16 v219, v173, s67, v219
  v_dot2_f32_bf16 v220, v169, s67, v220
  v_dot2_f32_bf16 v221, v174, s67, v221
  v_dot2_f32_bf16 v222, v170, s67, v222
  v_dot2_f32_bf16 v223, v175, s67, v223
  ds_write_b128 v194, v[216:219] offset:2048
  s_nop 1
  ds_write_b128 v194, v[220:223] offset:2064
  s_cbranch_execz Lg_72
  s_waitcnt lgkmcnt(0)
  s_barrier
  s_cmp_gt_u32 s3, 1
  s_cbranch_scc1 L_done
Lg_72:
  ds_read_b128 v[200:203], v195 offset:2048
  ds_read_b128 v[204:207], v195 offset:4096
  ds_read_b128 v[208:211], v195 offset:6144
  ds_read_b128 v[212:215], v195 offset:8192
  ds_read_b128 v[216:219], v195 offset:10240
  ds_read_b128 v[220:223], v195 offset:12288
  ds_read_b128 v[224:227], v195 offset:14336
  ds_read_b128 v[228:231], v195 offset:16384
  v_add_u32 v235, 0x4e000, v191
  s_waitcnt lgkmcnt(0)
  v_add_f32 v200, v200, v204
  v_add_f32 v201, v201, v205
  v_add_f32 v202, v202, v206
  v_add_f32 v203, v203, v207
  v_add_f32 v208, v208, v212
  v_add_f32 v209, v209, v213
  v_add_f32 v210, v210, v214
  v_add_f32 v211, v211, v215
  v_add_f32 v216, v216, v220
  v_add_f32 v217, v217, v221
  v_add_f32 v218, v218, v222
  v_add_f32 v219, v219, v223
  v_add_f32 v224, v224, v228
  v_add_f32 v225, v225, v229
  v_add_f32 v226, v226, v230
  v_add_f32 v227, v227, v231
  v_add_f32 v200, v200, v208
  v_add_f32 v201, v201, v209
  v_add_f32 v202, v202, v210
  v_add_f32 v203, v203, v211
  v_add_f32 v216, v216, v224
  v_add_f32 v217, v217, v225
  v_add_f32 v218, v218, v226
  v_add_f32 v219, v219, v227
  v_add_f32 v200, v200, v216
  v_add_f32 v201, v201, v217
  v_add_f32 v202, v202, v218
  v_add_f32 v203, v203, v219
  s_cbranch_execz Lg_73
  s_nop 0
  s_cmp_lg_u32 s62, 0
  s_cbranch_scc1 Ls_74
  global_store_dwordx4 v235, v[200:203], s[34:35] sc1
  s_branch Ls_75
Ls_74:
  global_store_dwordx4 v235, v[200:203], s[34:35]
Ls_75:
  s_nop 1
Lg_73:
L_t_s4:
  s_cbranch_execz Lg_76
  s_cmp_lg_u32 s3, 0
  s_cbranch_scc1 L_done
Lg_76:
  v_add_u32 v235, 0x4e000, v186
  v_mov_b32 v204, 0
  v_mov_b32 v205, 0
  v_mov_b32 v206, 0
  v_mov_b32 v207, 0
  s_cbranch_execz Lg_77
  s_mov_b32 s63, 262144
Lp_78:
  s_sub_u32 s63, s63, 1
  s_cbranch_scc1 Lq_79
  global_load_dwordx4 v[200:203], v235, s[34:35] sc1
  s_mov_b32 exec_hi, 0xffff
  global_load_dwordx4 v[204:207], v235, s[34:35] offset:1024 sc1
  s_mov_b64 exec, -1
  s_waitcnt vmcnt(0)
  v_max3_u32 v232, v200, v201, v202
  v_max3_u32 v232, v232, v203, v204
  v_max3_u32 v232, v232, v205, v206
  v_max_u32 v232, v232, v207
  v_cmp_eq_u32 vcc, -1, v232
  s_cbranch_vccnz Lp_78
Lq_79:
Lg_77:
  v_add_f32 v200, v200, v204
  v_add_f32 v201, v201, v205
  v_add_f32 v202, v202, v206
  v_add_f32 v203, v203, v207
  s_nop 0
  v_permlane32_swap_b32 v200, v202
  v_permlane32_swap_b32 v201, v203
  v_add_f32 v200, v200, v202
  v_add_f32 v201, v201, v203
  s_nop 1
  v_permlane16_swap_b32 v200, v201
  v_add_f32 v200, v200, v201
  s_nop 1
  v_add_f32_dpp v200, v200, v200 row_ror:8 row_mask:0xf bank_mask:0xf
  s_nop 1
  v_add_f32_dpp v200, v200, v200 row_ror:4 row_mask:0xf bank_mask:0xf
  v_cvt_pk_bf16_f32 v200, v200, v200
  v_lshlrev_b32 v200, 16, v200
  v_mul_f32 v200, v200, v180
  v_cvt_pk_bf16_f32 v200, v200, v200
  v_lshlrev_b32 v200, 16, v200
  v_add_f32 v200, v200, v182
  v_mov_b32 v235, v200
  s_nop 1
  v_permlane16_swap_b32 v200, v235
  v_cvt_pk_bf16_f32 v200, v200, v235
  s_cbranch_execz Lg_80
  s_and_b32 exec_lo, s6, 0xf
  s_and_b32 exec_hi, s7, 0xf
  global_store_dword v192, v200, s[30:31]
  s_branch L_done
Lg_80:
  s_branch L_tail_dry_ret
L_done:
L_end:
  s_endpgm
.fill (24576+256-(.-adaLN_cond__gqa_block_cached__geglu_ffn__decode_kernel))/4, 4, 0xbf810000
.section .rodata,"a"
.p2align 6
.amdhsa_kernel adaLN_cond__gqa_block_cached__geglu_ffn__decode_kernel
  .amdhsa_next_free_vgpr 256
  .amdhsa_next_free_sgpr 102
  .amdhsa_accum_offset 256
  .amdhsa_group_segment_fixed_size 0
  .amdhsa_kernarg_size 112
  .amdhsa_user_sgpr_count 2
  .amdhsa_user_sgpr_kernarg_segment_ptr 1
  .amdhsa_system_sgpr_workgroup_id_x 1
.end_amdhsa_kernel
```
